```python
import torch

def _softmax(x, axis=-1):
    return torch.softmax(x, dim=axis)
def _gelu(x):
    return torch.nn.functional.gelu(x, approximate="tanh")
def _silu(x):
    return torch.nn.functional.silu(x)
def _sigmoid(x):
    return torch.sigmoid(x)
def _layernorm(x, axis=-1, eps=1e-5):
    m = x.mean(dim=axis, keepdim=True)
    v = x.var(dim=axis, keepdim=True, unbiased=False)
    return (x - m) / torch.sqrt(v + eps)
def _scatter_add(tgt, idx, src, axis=0):
    return tgt.clone().index_add_(axis, idx, src)
def _segment_sum(src, seg, n):
    out = torch.zeros((n,) + src.shape[1:], dtype=src.dtype)
    return out.index_add_(0, seg, src)
def _pad(x, pw):
    flat = tuple(v for pair in reversed(pw) for v in pair)
    return torch.nn.functional.pad(x, flat)

kernel_name = 'parallel_sum__gqa_block_cached__glu_gated_reglu__decode'

def setup_inputs():

    _w = (lambda a: (lambda t: t.to(torch.bfloat16) if t.is_floating_point() else t)(torch.as_tensor(a)))
    def _A_setup():
        B, Sq, D = 1, 1, 448
        Hq, Hkv, Sk, Dh = 16, 8, 65536, 256
        assert Hq % Hkv == 0, (Hq, Hkv)
        return {
            "x": _w((lambda *s: torch.randn(*s, dtype=torch.bfloat16) * 0.05)(B, Sq, D)),
            "k_cache": _w((lambda *s: torch.randn(*s, dtype=torch.bfloat16) * 3.2)(B, Hkv, Sk, Dh)),
            "v_cache": _w((lambda *s: torch.randn(*s, dtype=torch.bfloat16) * 1.6)(B, Hkv, Sk, Dh)),
            "wq": _w((lambda *s: torch.randn(*s, dtype=torch.bfloat16) * 3.2)(D, Hq * Dh) * (D ** -0.5)),
            "wo": _w((lambda *s: torch.randn(*s, dtype=torch.bfloat16) * 1.6)(Hq * Dh, D) * ((Hq * Dh) ** -0.5)),
        }
    _A_in = _A_setup()

    def _B_setup():
        B, S, D, F = 1, 1, 448, 1792
        return {
            "x": _w((lambda *s: torch.randn(*s, dtype=torch.bfloat16) * 0.05)(B, S, D)),
            "W_gate": _w((lambda *s: torch.randn(*s, dtype=torch.bfloat16) * 1.6)(D, F) * (2.0 / D) ** 0.5),
            "W_up": _w((lambda *s: torch.randn(*s, dtype=torch.bfloat16) * 1.6)(D, F) * (2.0 / D) ** 0.5),
            "W_down": _w((lambda *s: torch.randn(*s, dtype=torch.bfloat16) * 1.6)(F, D) * (1.0 / F) ** 0.5),
        }
    _B_in = _B_setup()

    return {
        "A_x": _A_in["x"],
        "A_k_cache": _A_in["k_cache"],
        "A_v_cache": _A_in["v_cache"],
        "A_wq": _A_in["wq"],
        "A_wo": _A_in["wo"],
        "B_x": _B_in["x"],
        "B_W_gate": _B_in["W_gate"],
        "B_W_up": _B_in["W_up"],
        "B_W_down": _B_in["W_down"],
    }

def reference(A_x, A_k_cache, A_v_cache, A_wq, A_wo, B_x, B_W_gate, B_W_up, B_W_down):
    def _A_ref(x, k_cache, v_cache, wq, wo):
        B, Sq, D = x.shape
        Hq, Dh = 16, 256
        Hkv = k_cache.shape[1]
        rep = Hq // Hkv
        q = (lambda x, *d: x.permute(*d))((x @ wq).reshape(B, Sq, Hq, Dh), 0, 2, 1, 3)
        k = (lambda x, n, axis: torch.repeat_interleave(x, n, dim=axis))(k_cache, rep, axis=1)
        v = (lambda x, n, axis: torch.repeat_interleave(x, n, dim=axis))(v_cache, rep, axis=1)
        scores = torch.einsum("bhqd,bhkd->bhqk", q, k) * (Dh ** -0.5)
        p = _softmax(scores, axis=-1)
        o = torch.einsum("bhqk,bhkd->bhqd", p, v)
        return (lambda x, *d: x.permute(*d))(o, 0, 2, 1, 3).reshape(B, Sq, Hq * Dh) @ wo

    def _B_ref(x, W_gate, W_up, W_down):
        gate = torch.einsum("bsd,df->bsf", x, W_gate)
        up = torch.einsum("bsd,df->bsf", x, W_up)
        gate = gate * (lambda x, dt: x.to(dt))(gate > 0, gate.dtype)
        h = gate * up
        return torch.einsum("bsf,fd->bsd", h, W_down)

    x = A_x
    xn = _layernorm(x, axis=-1)
    return x + _A_ref(xn, A_k_cache, A_v_cache, A_wq, A_wo) + _B_ref(xn, B_W_gate, B_W_up, B_W_down)
```

```asm
; @launch grid=(256,1,1) block=(512,1,1) lds=42112
.amdgcn_target "amdgcn-amd-amdhsa--gfx950"
.text
.globl parallel_sum__gqa_block_cached__glu_gated_reglu__decode_kernel
.p2align 8
.type parallel_sum__gqa_block_cached__glu_gated_reglu__decode_kernel,@function
parallel_sum__gqa_block_cached__glu_gated_reglu__decode_kernel:
  s_cmp_ge_u32 s2, 256
  s_cbranch_scc1 L_end
  s_load_dwordx16 s[36:51], s[0:1], 0
  s_load_dwordx8 s[52:59], s[0:1], 64
  v_lshrrev_b32 v1, 6, v0
  v_and_b32 v0, 63, v0
  s_lshr_b32 s4, s2, 5
  v_readfirstlane_b32 s3, v1
  s_and_b32 s5, s2, 31
  s_and_b32 s6, s2, 7
  s_lshr_b32 s7, s2, 3
  s_and_b32 s7, s7, 3
  s_lshr_b32 s29, s2, 2
  s_lshr_b32 s33, s5, 2
  s_lshl_b32 s33, s33, 3
  s_add_u32 s33, s33, s4
  s_and_b32 s30, s2, 3
  s_mov_b32 s28, 1
  s_cmp_eq_u32 s30, 0
  s_cselect_b32 s28, 0, s28
  s_cmp_lt_u32 s33, 28
  s_cselect_b32 s31, 2, 1
  s_cmp_eq_u32 s30, 1
  s_cselect_b32 s28, s31, s28
  s_sub_u32 s89, s2, 0
  s_mov_b32 s60, 0x3db8aa3b
  s_waitcnt lgkmcnt(0)
  s_load_dword s35, s[58:59], 0
  s_lshl_b32 s30, s4, 25
  s_add_u32 s8, s38, s30
  s_addc_u32 s9, s39, 0
  s_and_b32 s9, s9, 0xffff
  s_mov_b32 s10, 0x2000000
  s_mov_b32 s11, 0x00020000
  s_add_u32 s12, s40, s30
  s_addc_u32 s13, s41, 0
  s_and_b32 s13, s13, 0xffff
  s_mov_b32 s14, 0x2000000
  s_mov_b32 s15, 0x00020000
  s_mov_b32 s16, s58
  s_and_b32 s17, s59, 0xffff
  s_mov_b32 s18, 8388608
  s_mov_b32 s19, 0x00020000
  s_cmp_eq_u32 s3, 7
  s_cbranch_scc1 L_control
L_worker:
  s_cmp_eq_u32 s28, 2
  s_cbranch_scc0 L_w_1
  s_cmp_eq_u32 s3, 6
  s_cbranch_scc1 L_ffn
L_w_1:
  s_cmp_eq_u32 s28, 0
  s_cbranch_scc1 L_wroleQ
  s_mov_b32 s32, 1
  s_branch L_prefetch
L_wroleQ:
  s_mov_b32 s20, s42
  s_and_b32 s21, s43, 0xffff
  s_mov_b32 s22, 3670016
  s_mov_b32 s23, 0x00020000
  v_lshrrev_b32 v62, 3, v0
  v_lshlrev_b32 v62, 13, v62
  v_and_b32 v1, 7, v0
  v_lshl_add_u32 v62, v1, 4, v62
  s_lshl_b32 s30, s3, 19
  s_lshl_b32 s31, s29, 7
  s_add_u32 s30, s30, s31
  s_add_u32 s31, s30, 0
  buffer_load_dwordx4 v[192:195], v62, s[20:23], s31 offen nt
  s_add_u32 s31, s30, 65536
  buffer_load_dwordx4 v[196:199], v62, s[20:23], s31 offen nt
  s_add_u32 s31, s30, 131072
  buffer_load_dwordx4 v[200:203], v62, s[20:23], s31 offen nt
  s_add_u32 s31, s30, 196608
  buffer_load_dwordx4 v[204:207], v62, s[20:23], s31 offen nt
  s_add_u32 s31, s30, 262144
  buffer_load_dwordx4 v[208:211], v62, s[20:23], s31 offen nt
  s_add_u32 s31, s30, 327680
  buffer_load_dwordx4 v[212:215], v62, s[20:23], s31 offen nt
  s_add_u32 s31, s30, 393216
  buffer_load_dwordx4 v[216:219], v62, s[20:23], s31 offen nt
  s_add_u32 s31, s30, 458752
  buffer_load_dwordx4 v[220:223], v62, s[20:23], s31 offen nt
  v_and_b32 v1, 1, v0
  v_lshlrev_b32 v1, 4, v1
  v_mov_b32 v31, 0xffff
  v_lshlrev_b32 v31, v1, v31
  v_bfe_u32 v1, v0, 1, 2
  v_cmp_eq_u32 vcc, 0, v1
  s_nop 1
  v_cndmask_b32 v8, 0, v31, vcc
  v_cmp_eq_u32 vcc, 1, v1
  s_nop 1
  v_cndmask_b32 v9, 0, v31, vcc
  v_cmp_eq_u32 vcc, 2, v1
  s_nop 1
  v_cndmask_b32 v10, 0, v31, vcc
  v_cmp_eq_u32 vcc, 3, v1
  s_nop 1
  v_cndmask_b32 v11, 0, v31, vcc
  s_barrier
  v_lshrrev_b32 v63, 3, v0
  v_lshlrev_b32 v63, 2, v63
  s_lshl_b32 s31, s3, 8
  s_add_u32 s31, s31, 14592
  v_add_u32 v63, s31, v63
  s_barrier
  ds_read_b32 v32, v63 offset:0
  ds_read_b32 v33, v63 offset:32
  ds_read_b32 v34, v63 offset:64
  ds_read_b32 v35, v63 offset:96
  ds_read_b32 v36, v63 offset:128
  ds_read_b32 v37, v63 offset:160
  ds_read_b32 v38, v63 offset:192
  ds_read_b32 v39, v63 offset:224
  s_waitcnt vmcnt(0) lgkmcnt(0)
  v_and_b32 v48, v8, v32
  v_and_b32 v49, v9, v32
  v_and_b32 v50, v10, v32
  v_and_b32 v51, v11, v32
  s_nop 1
  v_mfma_f32_16x16x32_bf16 v[56:59], v[48:51], v[192:195], 0
  v_and_b32 v52, v8, v33
  v_and_b32 v53, v9, v33
  v_and_b32 v54, v10, v33
  v_and_b32 v55, v11, v33
  s_nop 1
  v_mfma_f32_16x16x32_bf16 v[56:59], v[52:55], v[196:199], v[56:59]
  v_and_b32 v48, v8, v34
  v_and_b32 v49, v9, v34
  v_and_b32 v50, v10, v34
  v_and_b32 v51, v11, v34
  s_nop 1
  v_mfma_f32_16x16x32_bf16 v[56:59], v[48:51], v[200:203], v[56:59]
  v_and_b32 v52, v8, v35
  v_and_b32 v53, v9, v35
  v_and_b32 v54, v10, v35
  v_and_b32 v55, v11, v35
  s_nop 1
  v_mfma_f32_16x16x32_bf16 v[56:59], v[52:55], v[204:207], v[56:59]
  v_and_b32 v48, v8, v36
  v_and_b32 v49, v9, v36
  v_and_b32 v50, v10, v36
  v_and_b32 v51, v11, v36
  s_nop 1
  v_mfma_f32_16x16x32_bf16 v[56:59], v[48:51], v[208:211], v[56:59]
  v_and_b32 v52, v8, v37
  v_and_b32 v53, v9, v37
  v_and_b32 v54, v10, v37
  v_and_b32 v55, v11, v37
  s_nop 1
  v_mfma_f32_16x16x32_bf16 v[56:59], v[52:55], v[212:215], v[56:59]
  v_and_b32 v48, v8, v38
  v_and_b32 v49, v9, v38
  v_and_b32 v50, v10, v38
  v_and_b32 v51, v11, v38
  s_nop 1
  v_mfma_f32_16x16x32_bf16 v[56:59], v[48:51], v[216:219], v[56:59]
  v_and_b32 v52, v8, v39
  v_and_b32 v53, v9, v39
  v_and_b32 v54, v10, v39
  v_and_b32 v55, v11, v39
  s_nop 1
  v_mfma_f32_16x16x32_bf16 v[56:59], v[52:55], v[220:223], v[56:59]
  v_lshlrev_b32 v62, 4, v0
  s_lshl_b32 s31, s3, 10
  s_add_u32 s31, s31, 17664
  v_add_u32 v62, s31, v62
  s_nop 7
  ds_write_b128 v62, v[56:59]
  s_waitcnt lgkmcnt(0)
  s_barrier
  s_barrier
L_prefetch0:
  s_mov_b32 s32, 0
L_prefetch:
  v_and_b32 v2, 15, v0
  v_lshrrev_b32 v3, 4, v0
  v_lshrrev_b32 v4, 2, v2
  v_lshlrev_b32 v4, 9, v4
  v_lshl_add_u32 v4, v3, 6, v4
  v_and_b32 v1, 3, v2
  v_lshl_add_u32 v4, v1, 4, v4
  v_lshlrev_b32 v6, 9, v3
  v_lshl_add_u32 v6, v2, 4, v6
  s_mul_i32 s61, s6, 448
  s_mul_i32 s30, s7, 7
  s_add_u32 s61, s61, s30
  s_add_u32 s61, s61, s3
  s_add_u32 s70, s61, 28
  s_add_u32 s71, s61, 56
  s_lshr_b32 s72, s61, 0
  s_mul_i32 s72, s72, 8192
  s_and_b32 s73, s61, 0
  s_lshl_b32 s73, s73, 11
  s_add_u32 s72, s72, s73
  s_add_u32 s73, s72, 2048
  s_add_u32 s74, s72, 4096
  s_add_u32 s75, s72, 6144
  buffer_load_dwordx4 v[64:67], v4, s[8:11], s72 offen offset:0 nt
  buffer_load_dwordx4 v[68:71], v4, s[8:11], s72 offen offset:256 nt
  buffer_load_dwordx4 v[72:75], v4, s[8:11], s73 offen offset:0 nt
  buffer_load_dwordx4 v[76:79], v4, s[8:11], s73 offen offset:256 nt
  buffer_load_dwordx4 v[80:83], v4, s[8:11], s74 offen offset:0 nt
  buffer_load_dwordx4 v[84:87], v4, s[8:11], s74 offen offset:256 nt
  buffer_load_dwordx4 v[88:91], v4, s[8:11], s75 offen offset:0 nt
  buffer_load_dwordx4 v[92:95], v4, s[8:11], s75 offen offset:256 nt
  buffer_load_dwordx4 v[96:99], v6, s[12:15], s72 offen offset:0 nt
  buffer_load_dwordx4 v[100:103], v6, s[12:15], s72 offen offset:256 nt
  buffer_load_dwordx4 v[104:107], v6, s[12:15], s73 offen offset:0 nt
  buffer_load_dwordx4 v[108:111], v6, s[12:15], s73 offen offset:256 nt
  buffer_load_dwordx4 v[112:115], v6, s[12:15], s74 offen offset:0 nt
  buffer_load_dwordx4 v[116:119], v6, s[12:15], s74 offen offset:256 nt
  buffer_load_dwordx4 v[120:123], v6, s[12:15], s75 offen offset:0 nt
  buffer_load_dwordx4 v[124:127], v6, s[12:15], s75 offen offset:256 nt
  s_cmp_lg_u32 s32, 1
  s_cbranch_scc1 L_w_2
  s_barrier
L_w_2:
  v_and_b32 v1, 1, v0
  v_lshlrev_b32 v1, 4, v1
  v_mov_b32 v31, 0xffff
  v_lshlrev_b32 v31, v1, v31
  v_bfe_u32 v1, v0, 1, 2
  v_cmp_eq_u32 vcc, 0, v1
  s_nop 1
  v_cndmask_b32 v8, 0, v31, vcc
  v_cmp_eq_u32 vcc, 1, v1
  s_nop 1
  v_cndmask_b32 v9, 0, v31, vcc
  v_cmp_eq_u32 vcc, 2, v1
  s_nop 1
  v_cndmask_b32 v10, 0, v31, vcc
  v_cmp_eq_u32 vcc, 3, v1
  s_nop 1
  v_cndmask_b32 v11, 0, v31, vcc
  s_waitcnt lgkmcnt(0)
  s_add_u32 s34, s35, 1
  s_cmp_eq_u32 s32, 2
  s_cbranch_scc1 L_burst
  s_waitcnt vmcnt(0)
  s_lshr_b32 s72, s70, 0
  s_mul_i32 s72, s72, 8192
  s_and_b32 s73, s70, 0
  s_lshl_b32 s73, s73, 11
  s_add_u32 s72, s72, s73
  s_add_u32 s73, s72, 2048
  s_add_u32 s74, s72, 4096
  s_add_u32 s75, s72, 6144
  buffer_load_dwordx4 v[128:131], v4, s[8:11], s72 offen offset:0 nt
  buffer_load_dwordx4 v[132:135], v4, s[8:11], s72 offen offset:256 nt
  buffer_load_dwordx4 v[136:139], v4, s[8:11], s73 offen offset:0 nt
  buffer_load_dwordx4 v[140:143], v4, s[8:11], s73 offen offset:256 nt
  buffer_load_dwordx4 v[144:147], v4, s[8:11], s74 offen offset:0 nt
  buffer_load_dwordx4 v[148:151], v4, s[8:11], s74 offen offset:256 nt
  buffer_load_dwordx4 v[152:155], v4, s[8:11], s75 offen offset:0 nt
  buffer_load_dwordx4 v[156:159], v4, s[8:11], s75 offen offset:256 nt
  s_waitcnt vmcnt(0)
  buffer_load_dwordx4 v[160:163], v6, s[12:15], s72 offen offset:0 nt
  buffer_load_dwordx4 v[164:167], v6, s[12:15], s72 offen offset:256 nt
  buffer_load_dwordx4 v[168:171], v6, s[12:15], s73 offen offset:0 nt
  buffer_load_dwordx4 v[172:175], v6, s[12:15], s73 offen offset:256 nt
  buffer_load_dwordx4 v[176:179], v6, s[12:15], s74 offen offset:0 nt
  buffer_load_dwordx4 v[180:183], v6, s[12:15], s74 offen offset:256 nt
  buffer_load_dwordx4 v[184:187], v6, s[12:15], s75 offen offset:0 nt
  buffer_load_dwordx4 v[188:191], v6, s[12:15], s75 offen offset:256 nt
  s_waitcnt vmcnt(0)
  s_lshr_b32 s72, s71, 0
  s_mul_i32 s72, s72, 8192
  s_and_b32 s73, s71, 0
  s_lshl_b32 s73, s73, 11
  s_add_u32 s72, s72, s73
  s_add_u32 s73, s72, 2048
  s_add_u32 s74, s72, 4096
  s_add_u32 s75, s72, 6144
  buffer_load_dwordx4 v[192:195], v4, s[8:11], s72 offen offset:0 nt
  buffer_load_dwordx4 v[196:199], v4, s[8:11], s72 offen offset:256 nt
  buffer_load_dwordx4 v[200:203], v4, s[8:11], s73 offen offset:0 nt
  buffer_load_dwordx4 v[204:207], v4, s[8:11], s73 offen offset:256 nt
  buffer_load_dwordx4 v[208:211], v4, s[8:11], s74 offen offset:0 nt
  buffer_load_dwordx4 v[212:215], v4, s[8:11], s74 offen offset:256 nt
  buffer_load_dwordx4 v[216:219], v4, s[8:11], s75 offen offset:0 nt
  buffer_load_dwordx4 v[220:223], v4, s[8:11], s75 offen offset:256 nt
  s_waitcnt vmcnt(0)
  buffer_load_dwordx4 v[224:227], v6, s[12:15], s72 offen offset:0 nt
  buffer_load_dwordx4 v[228:231], v6, s[12:15], s72 offen offset:256 nt
  buffer_load_dwordx4 v[232:235], v6, s[12:15], s73 offen offset:0 nt
  buffer_load_dwordx4 v[236:239], v6, s[12:15], s73 offen offset:256 nt
  buffer_load_dwordx4 v[240:243], v6, s[12:15], s74 offen offset:0 nt
  buffer_load_dwordx4 v[244:247], v6, s[12:15], s74 offen offset:256 nt
  buffer_load_dwordx4 v[248:251], v6, s[12:15], s75 offen offset:0 nt
  buffer_load_dwordx4 v[252:255], v6, s[12:15], s75 offen offset:256 nt
  s_branch L_pfdone
L_burst:
  s_lshr_b32 s72, s70, 0
  s_mul_i32 s72, s72, 8192
  s_and_b32 s73, s70, 0
  s_lshl_b32 s73, s73, 11
  s_add_u32 s72, s72, s73
  s_add_u32 s73, s72, 2048
  s_add_u32 s74, s72, 4096
  s_add_u32 s75, s72, 6144
  buffer_load_dwordx4 v[128:131], v4, s[8:11], s72 offen offset:0 nt
  buffer_load_dwordx4 v[132:135], v4, s[8:11], s72 offen offset:256 nt
  buffer_load_dwordx4 v[136:139], v4, s[8:11], s73 offen offset:0 nt
  buffer_load_dwordx4 v[140:143], v4, s[8:11], s73 offen offset:256 nt
  buffer_load_dwordx4 v[144:147], v4, s[8:11], s74 offen offset:0 nt
  buffer_load_dwordx4 v[148:151], v4, s[8:11], s74 offen offset:256 nt
  buffer_load_dwordx4 v[152:155], v4, s[8:11], s75 offen offset:0 nt
  buffer_load_dwordx4 v[156:159], v4, s[8:11], s75 offen offset:256 nt
  buffer_load_dwordx4 v[160:163], v6, s[12:15], s72 offen offset:0 nt
  buffer_load_dwordx4 v[164:167], v6, s[12:15], s72 offen offset:256 nt
  buffer_load_dwordx4 v[168:171], v6, s[12:15], s73 offen offset:0 nt
  buffer_load_dwordx4 v[172:175], v6, s[12:15], s73 offen offset:256 nt
  buffer_load_dwordx4 v[176:179], v6, s[12:15], s74 offen offset:0 nt
  buffer_load_dwordx4 v[180:183], v6, s[12:15], s74 offen offset:256 nt
  buffer_load_dwordx4 v[184:187], v6, s[12:15], s75 offen offset:0 nt
  buffer_load_dwordx4 v[188:191], v6, s[12:15], s75 offen offset:256 nt
  s_lshr_b32 s72, s71, 0
  s_mul_i32 s72, s72, 8192
  s_and_b32 s73, s71, 0
  s_lshl_b32 s73, s73, 11
  s_add_u32 s72, s72, s73
  s_add_u32 s73, s72, 2048
  s_add_u32 s74, s72, 4096
  s_add_u32 s75, s72, 6144
  buffer_load_dwordx4 v[192:195], v4, s[8:11], s72 offen offset:0 nt
  buffer_load_dwordx4 v[196:199], v4, s[8:11], s72 offen offset:256 nt
  buffer_load_dwordx4 v[200:203], v4, s[8:11], s73 offen offset:0 nt
  buffer_load_dwordx4 v[204:207], v4, s[8:11], s73 offen offset:256 nt
  buffer_load_dwordx4 v[208:211], v4, s[8:11], s74 offen offset:0 nt
  buffer_load_dwordx4 v[212:215], v4, s[8:11], s74 offen offset:256 nt
  buffer_load_dwordx4 v[216:219], v4, s[8:11], s75 offen offset:0 nt
  buffer_load_dwordx4 v[220:223], v4, s[8:11], s75 offen offset:256 nt
  buffer_load_dwordx4 v[224:227], v6, s[12:15], s72 offen offset:0 nt
  buffer_load_dwordx4 v[228:231], v6, s[12:15], s72 offen offset:256 nt
  buffer_load_dwordx4 v[232:235], v6, s[12:15], s73 offen offset:0 nt
  buffer_load_dwordx4 v[236:239], v6, s[12:15], s73 offen offset:256 nt
  buffer_load_dwordx4 v[240:243], v6, s[12:15], s74 offen offset:0 nt
  buffer_load_dwordx4 v[244:247], v6, s[12:15], s74 offen offset:256 nt
  buffer_load_dwordx4 v[248:251], v6, s[12:15], s75 offen offset:0 nt
  buffer_load_dwordx4 v[252:255], v6, s[12:15], s75 offen offset:256 nt
  s_waitcnt vmcnt(8)
L_pfdone:
  v_mov_b32 v62, 4
L_spinq_3:
  ds_read_b32 v31, v62
  s_waitcnt lgkmcnt(0)
  v_readfirstlane_b32 s66, v31
  s_nop 1
  s_cmp_lg_u32 s66, 0
  s_cbranch_scc1 L_spinqd_4
  s_sleep 1
  s_branch L_spinq_3
L_spinqd_4:
  v_lshrrev_b32 v62, 3, v2
  v_lshlrev_b32 v62, 9, v62
  v_lshl_add_u32 v62, v3, 6, v62
  v_and_b32 v1, 3, v2
  v_lshl_add_u32 v62, v1, 4, v62
  ds_read_b128 v[12:15], v62 offset:16384
  ds_read_b128 v[16:19], v62 offset:16640
  v_mov_b32 v20, 0
  v_mov_b32 v21, 0
  v_mov_b32 v22, 0
  v_mov_b32 v23, 0
  v_mov_b32 v24, 0
  v_mov_b32 v25, 0
  v_mov_b32 v26, 0
  v_mov_b32 v27, 0
  v_mov_b32 v28, 0xff800000
  v_mov_b32 v29, 0xff800000
  v_mov_b32 v30, 0
  v_mov_b32 v60, 0
  v_mov_b32 v61, 1
  s_mov_b32 s64, -1
  s_mov_b32 s65, 0
  s_waitcnt lgkmcnt(0)
  s_cmp_ge_u32 s3, 4
  s_cbranch_scc1 L_static_only
  s_mov_b64 exec, 1
  ds_add_rtn_u32 v31, v60, v61
  s_mov_b64 exec, -1
  v_mfma_f32_16x16x32_bf16 v[32:35], v[64:67], v[12:15], 0
  v_mfma_f32_16x16x32_bf16 v[36:39], v[72:75], v[12:15], 0
  v_mfma_f32_16x16x32_bf16 v[40:43], v[80:83], v[12:15], 0
  v_mfma_f32_16x16x32_bf16 v[44:47], v[88:91], v[12:15], 0
  v_mfma_f32_16x16x32_bf16 v[32:35], v[68:71], v[16:19], v[32:35]
  v_mfma_f32_16x16x32_bf16 v[36:39], v[76:79], v[16:19], v[36:39]
  v_mfma_f32_16x16x32_bf16 v[40:43], v[84:87], v[16:19], v[40:43]
  v_mfma_f32_16x16x32_bf16 v[44:47], v[92:95], v[16:19], v[44:47]
  s_waitcnt lgkmcnt(0)
  s_mov_b64 exec, 1
  v_lshlrev_b32 v62, 2, v31
L_spin_6:
  ds_read_b32 v31, v62 offset:64
  s_waitcnt lgkmcnt(0)
  v_readfirstlane_b32 s66, v31
  s_nop 1
  s_cmp_eq_u32 s66, -1
  s_cbranch_scc1 L_spin_6
  s_mov_b64 exec, -1
  s_cmp_ge_u32 s66, 4096
  s_cbranch_scc1 L_drain_5
  s_lshr_b32 s72, s66, 0
  s_mul_i32 s72, s72, 8192
  s_and_b32 s73, s66, 0
  s_lshl_b32 s73, s73, 11
  s_add_u32 s72, s72, s73
  s_add_u32 s73, s72, 2048
  s_add_u32 s74, s72, 4096
  s_add_u32 s75, s72, 6144
  buffer_load_dwordx4 v[64:67], v4, s[8:11], s72 offen offset:0 nt
  buffer_load_dwordx4 v[68:71], v4, s[8:11], s72 offen offset:256 nt
  buffer_load_dwordx4 v[72:75], v4, s[8:11], s73 offen offset:0 nt
  buffer_load_dwordx4 v[76:79], v4, s[8:11], s73 offen offset:256 nt
  buffer_load_dwordx4 v[80:83], v4, s[8:11], s74 offen offset:0 nt
  buffer_load_dwordx4 v[84:87], v4, s[8:11], s74 offen offset:256 nt
  buffer_load_dwordx4 v[88:91], v4, s[8:11], s75 offen offset:0 nt
  buffer_load_dwordx4 v[92:95], v4, s[8:11], s75 offen offset:256 nt
  v_mov_b32_dpp v48, v32 quad_perm:[0,0,0,0] row_mask:0xf bank_mask:0xf
  v_mov_b32_dpp v49, v36 quad_perm:[0,0,0,0] row_mask:0xf bank_mask:0xf
  v_mov_b32_dpp v50, v40 quad_perm:[0,0,0,0] row_mask:0xf bank_mask:0xf
  v_mov_b32_dpp v51, v44 quad_perm:[0,0,0,0] row_mask:0xf bank_mask:0xf
  v_add_f32_dpp v48, v33, v48 quad_perm:[1,1,1,1] row_mask:0xf bank_mask:0xf
  v_add_f32_dpp v49, v37, v49 quad_perm:[1,1,1,1] row_mask:0xf bank_mask:0xf
  v_add_f32_dpp v50, v41, v50 quad_perm:[1,1,1,1] row_mask:0xf bank_mask:0xf
  v_add_f32_dpp v51, v45, v51 quad_perm:[1,1,1,1] row_mask:0xf bank_mask:0xf
  v_add_f32_dpp v48, v34, v48 quad_perm:[2,2,2,2] row_mask:0xf bank_mask:0xf
  v_add_f32_dpp v49, v38, v49 quad_perm:[2,2,2,2] row_mask:0xf bank_mask:0xf
  v_add_f32_dpp v50, v42, v50 quad_perm:[2,2,2,2] row_mask:0xf bank_mask:0xf
  v_add_f32_dpp v51, v46, v51 quad_perm:[2,2,2,2] row_mask:0xf bank_mask:0xf
  v_add_f32_dpp v48, v35, v48 quad_perm:[3,3,3,3] row_mask:0xf bank_mask:0xf
  v_add_f32_dpp v49, v39, v49 quad_perm:[3,3,3,3] row_mask:0xf bank_mask:0xf
  v_add_f32_dpp v50, v43, v50 quad_perm:[3,3,3,3] row_mask:0xf bank_mask:0xf
  v_add_f32_dpp v51, v47, v51 quad_perm:[3,3,3,3] row_mask:0xf bank_mask:0xf
  v_cvt_pk_bf16_f32 v52, v48, v49
  v_cvt_pk_bf16_f32 v53, v50, v51
  v_lshlrev_b32 v48, 16, v52
  v_and_b32 v49, 0xffff0000, v52
  v_lshlrev_b32 v50, 16, v53
  v_and_b32 v51, 0xffff0000, v53
  v_max3_f32 v52, v48, v49, v50
  v_max_f32 v52, v52, v51
  v_cmp_gt_f32 vcc, v52, v28
  s_nop 0
  s_cbranch_vccnz L_rare_7
L_back_8:
  v_fma_f32 v52, v48, s60, -v29
  v_fma_f32 v53, v49, s60, -v29
  v_fma_f32 v54, v50, s60, -v29
  v_fma_f32 v55, v51, s60, -v29
  v_exp_f32 v52, v52
  v_exp_f32 v53, v53
  v_exp_f32 v54, v54
  v_exp_f32 v55, v55
  s_nop 0
  v_cvt_pk_bf16_f32 v56, v52, v52
  v_cvt_pk_bf16_f32 v57, v53, v53
  v_cvt_pk_bf16_f32 v58, v54, v54
  v_cvt_pk_bf16_f32 v59, v55, v55
  v_add_f32 v52, v52, v53
  v_add_f32 v54, v54, v55
  v_add_f32 v30, v30, v52
  v_add_f32 v30, v30, v54
  v_and_b32 v32, v8, v56
  v_and_b32 v33, v9, v56
  v_and_b32 v34, v10, v56
  v_and_b32 v35, v11, v56
  s_nop 1
  v_mfma_f32_16x16x32_bf16 v[20:23], v[32:35], v[96:99], v[20:23]
  v_mfma_f32_16x16x32_bf16 v[24:27], v[32:35], v[100:103], v[24:27]
  v_and_b32 v36, v8, v57
  v_and_b32 v37, v9, v57
  v_and_b32 v38, v10, v57
  v_and_b32 v39, v11, v57
  s_nop 1
  v_mfma_f32_16x16x32_bf16 v[20:23], v[36:39], v[104:107], v[20:23]
  v_mfma_f32_16x16x32_bf16 v[24:27], v[36:39], v[108:111], v[24:27]
  v_and_b32 v32, v8, v58
  v_and_b32 v33, v9, v58
  v_and_b32 v34, v10, v58
  v_and_b32 v35, v11, v58
  s_nop 1
  v_mfma_f32_16x16x32_bf16 v[20:23], v[32:35], v[112:115], v[20:23]
  v_mfma_f32_16x16x32_bf16 v[24:27], v[32:35], v[116:119], v[24:27]
  v_and_b32 v36, v8, v59
  v_and_b32 v37, v9, v59
  v_and_b32 v38, v10, v59
  v_and_b32 v39, v11, v59
  s_nop 1
  v_mfma_f32_16x16x32_bf16 v[20:23], v[36:39], v[120:123], v[20:23]
  v_mfma_f32_16x16x32_bf16 v[24:27], v[36:39], v[124:127], v[24:27]
  buffer_load_dwordx4 v[96:99], v6, s[12:15], s72 offen offset:0 nt
  buffer_load_dwordx4 v[100:103], v6, s[12:15], s72 offen offset:256 nt
  buffer_load_dwordx4 v[104:107], v6, s[12:15], s73 offen offset:0 nt
  buffer_load_dwordx4 v[108:111], v6, s[12:15], s73 offen offset:256 nt
  buffer_load_dwordx4 v[112:115], v6, s[12:15], s74 offen offset:0 nt
  buffer_load_dwordx4 v[116:119], v6, s[12:15], s74 offen offset:256 nt
  buffer_load_dwordx4 v[120:123], v6, s[12:15], s75 offen offset:0 nt
  buffer_load_dwordx4 v[124:127], v6, s[12:15], s75 offen offset:256 nt
  v_mfma_f32_16x16x32_bf16 v[32:35], v[128:131], v[12:15], 0
  v_mfma_f32_16x16x32_bf16 v[36:39], v[136:139], v[12:15], 0
  v_mfma_f32_16x16x32_bf16 v[40:43], v[144:147], v[12:15], 0
  v_mfma_f32_16x16x32_bf16 v[44:47], v[152:155], v[12:15], 0
  v_mfma_f32_16x16x32_bf16 v[32:35], v[132:135], v[16:19], v[32:35]
  v_mfma_f32_16x16x32_bf16 v[36:39], v[140:143], v[16:19], v[36:39]
  v_mfma_f32_16x16x32_bf16 v[40:43], v[148:151], v[16:19], v[40:43]
  v_mfma_f32_16x16x32_bf16 v[44:47], v[156:159], v[16:19], v[44:47]
  s_nop 7
  v_mov_b32_dpp v48, v32 quad_perm:[0,0,0,0] row_mask:0xf bank_mask:0xf
  v_mov_b32_dpp v49, v36 quad_perm:[0,0,0,0] row_mask:0xf bank_mask:0xf
  v_mov_b32_dpp v50, v40 quad_perm:[0,0,0,0] row_mask:0xf bank_mask:0xf
  v_mov_b32_dpp v51, v44 quad_perm:[0,0,0,0] row_mask:0xf bank_mask:0xf
  v_add_f32_dpp v48, v33, v48 quad_perm:[1,1,1,1] row_mask:0xf bank_mask:0xf
  v_add_f32_dpp v49, v37, v49 quad_perm:[1,1,1,1] row_mask:0xf bank_mask:0xf
  v_add_f32_dpp v50, v41, v50 quad_perm:[1,1,1,1] row_mask:0xf bank_mask:0xf
  v_add_f32_dpp v51, v45, v51 quad_perm:[1,1,1,1] row_mask:0xf bank_mask:0xf
  v_add_f32_dpp v48, v34, v48 quad_perm:[2,2,2,2] row_mask:0xf bank_mask:0xf
  v_add_f32_dpp v49, v38, v49 quad_perm:[2,2,2,2] row_mask:0xf bank_mask:0xf
  v_add_f32_dpp v50, v42, v50 quad_perm:[2,2,2,2] row_mask:0xf bank_mask:0xf
  v_add_f32_dpp v51, v46, v51 quad_perm:[2,2,2,2] row_mask:0xf bank_mask:0xf
  v_add_f32_dpp v48, v35, v48 quad_perm:[3,3,3,3] row_mask:0xf bank_mask:0xf
  v_add_f32_dpp v49, v39, v49 quad_perm:[3,3,3,3] row_mask:0xf bank_mask:0xf
  v_add_f32_dpp v50, v43, v50 quad_perm:[3,3,3,3] row_mask:0xf bank_mask:0xf
  v_add_f32_dpp v51, v47, v51 quad_perm:[3,3,3,3] row_mask:0xf bank_mask:0xf
  v_cvt_pk_bf16_f32 v52, v48, v49
  v_cvt_pk_bf16_f32 v53, v50, v51
  v_lshlrev_b32 v48, 16, v52
  v_and_b32 v49, 0xffff0000, v52
  v_lshlrev_b32 v50, 16, v53
  v_and_b32 v51, 0xffff0000, v53
  v_max3_f32 v52, v48, v49, v50
  v_max_f32 v52, v52, v51
  v_cmp_gt_f32 vcc, v52, v28
  s_nop 0
  s_cbranch_vccnz L_rare_9
L_back_10:
  v_fma_f32 v52, v48, s60, -v29
  v_fma_f32 v53, v49, s60, -v29
  v_fma_f32 v54, v50, s60, -v29
  v_fma_f32 v55, v51, s60, -v29
  v_exp_f32 v52, v52
  v_exp_f32 v53, v53
  v_exp_f32 v54, v54
  v_exp_f32 v55, v55
  s_nop 0
  v_cvt_pk_bf16_f32 v56, v52, v52
  v_cvt_pk_bf16_f32 v57, v53, v53
  v_cvt_pk_bf16_f32 v58, v54, v54
  v_cvt_pk_bf16_f32 v59, v55, v55
  v_add_f32 v52, v52, v53
  v_add_f32 v54, v54, v55
  v_add_f32 v30, v30, v52
  v_add_f32 v30, v30, v54
  v_and_b32 v32, v8, v56
  v_and_b32 v33, v9, v56
  v_and_b32 v34, v10, v56
  v_and_b32 v35, v11, v56
  s_nop 1
  v_mfma_f32_16x16x32_bf16 v[20:23], v[32:35], v[160:163], v[20:23]
  v_mfma_f32_16x16x32_bf16 v[24:27], v[32:35], v[164:167], v[24:27]
  v_and_b32 v36, v8, v57
  v_and_b32 v37, v9, v57
  v_and_b32 v38, v10, v57
  v_and_b32 v39, v11, v57
  s_nop 1
  v_mfma_f32_16x16x32_bf16 v[20:23], v[36:39], v[168:171], v[20:23]
  v_mfma_f32_16x16x32_bf16 v[24:27], v[36:39], v[172:175], v[24:27]
  v_and_b32 v32, v8, v58
  v_and_b32 v33, v9, v58
  v_and_b32 v34, v10, v58
  v_and_b32 v35, v11, v58
  s_nop 1
  v_mfma_f32_16x16x32_bf16 v[20:23], v[32:35], v[176:179], v[20:23]
  v_mfma_f32_16x16x32_bf16 v[24:27], v[32:35], v[180:183], v[24:27]
  v_and_b32 v36, v8, v59
  v_and_b32 v37, v9, v59
  v_and_b32 v38, v10, v59
  v_and_b32 v39, v11, v59
  s_nop 1
  v_mfma_f32_16x16x32_bf16 v[20:23], v[36:39], v[184:187], v[20:23]
  v_mfma_f32_16x16x32_bf16 v[24:27], v[36:39], v[188:191], v[24:27]
  v_mfma_f32_16x16x32_bf16 v[32:35], v[192:195], v[12:15], 0
  v_mfma_f32_16x16x32_bf16 v[36:39], v[200:203], v[12:15], 0
  v_mfma_f32_16x16x32_bf16 v[40:43], v[208:211], v[12:15], 0
  v_mfma_f32_16x16x32_bf16 v[44:47], v[216:219], v[12:15], 0
  v_mfma_f32_16x16x32_bf16 v[32:35], v[196:199], v[16:19], v[32:35]
  v_mfma_f32_16x16x32_bf16 v[36:39], v[204:207], v[16:19], v[36:39]
  v_mfma_f32_16x16x32_bf16 v[40:43], v[212:215], v[16:19], v[40:43]
  v_mfma_f32_16x16x32_bf16 v[44:47], v[220:223], v[16:19], v[44:47]
  s_nop 7
  v_mov_b32_dpp v48, v32 quad_perm:[0,0,0,0] row_mask:0xf bank_mask:0xf
  v_mov_b32_dpp v49, v36 quad_perm:[0,0,0,0] row_mask:0xf bank_mask:0xf
  v_mov_b32_dpp v50, v40 quad_perm:[0,0,0,0] row_mask:0xf bank_mask:0xf
  v_mov_b32_dpp v51, v44 quad_perm:[0,0,0,0] row_mask:0xf bank_mask:0xf
  v_add_f32_dpp v48, v33, v48 quad_perm:[1,1,1,1] row_mask:0xf bank_mask:0xf
  v_add_f32_dpp v49, v37, v49 quad_perm:[1,1,1,1] row_mask:0xf bank_mask:0xf
  v_add_f32_dpp v50, v41, v50 quad_perm:[1,1,1,1] row_mask:0xf bank_mask:0xf
  v_add_f32_dpp v51, v45, v51 quad_perm:[1,1,1,1] row_mask:0xf bank_mask:0xf
  v_add_f32_dpp v48, v34, v48 quad_perm:[2,2,2,2] row_mask:0xf bank_mask:0xf
  v_add_f32_dpp v49, v38, v49 quad_perm:[2,2,2,2] row_mask:0xf bank_mask:0xf
  v_add_f32_dpp v50, v42, v50 quad_perm:[2,2,2,2] row_mask:0xf bank_mask:0xf
  v_add_f32_dpp v51, v46, v51 quad_perm:[2,2,2,2] row_mask:0xf bank_mask:0xf
  v_add_f32_dpp v48, v35, v48 quad_perm:[3,3,3,3] row_mask:0xf bank_mask:0xf
  v_add_f32_dpp v49, v39, v49 quad_perm:[3,3,3,3] row_mask:0xf bank_mask:0xf
  v_add_f32_dpp v50, v43, v50 quad_perm:[3,3,3,3] row_mask:0xf bank_mask:0xf
  v_add_f32_dpp v51, v47, v51 quad_perm:[3,3,3,3] row_mask:0xf bank_mask:0xf
  v_cvt_pk_bf16_f32 v52, v48, v49
  v_cvt_pk_bf16_f32 v53, v50, v51
  v_lshlrev_b32 v48, 16, v52
  v_and_b32 v49, 0xffff0000, v52
  v_lshlrev_b32 v50, 16, v53
  v_and_b32 v51, 0xffff0000, v53
  v_max3_f32 v52, v48, v49, v50
  v_max_f32 v52, v52, v51
  v_cmp_gt_f32 vcc, v52, v28
  s_nop 0
  s_cbranch_vccnz L_rare_11
L_back_12:
  v_fma_f32 v52, v48, s60, -v29
  v_fma_f32 v53, v49, s60, -v29
  v_fma_f32 v54, v50, s60, -v29
  v_fma_f32 v55, v51, s60, -v29
  v_exp_f32 v52, v52
  v_exp_f32 v53, v53
  v_exp_f32 v54, v54
  v_exp_f32 v55, v55
  s_nop 0
  v_cvt_pk_bf16_f32 v56, v52, v52
  v_cvt_pk_bf16_f32 v57, v53, v53
  v_cvt_pk_bf16_f32 v58, v54, v54
  v_cvt_pk_bf16_f32 v59, v55, v55
  v_add_f32 v52, v52, v53
  v_add_f32 v54, v54, v55
  v_add_f32 v30, v30, v52
  v_add_f32 v30, v30, v54
  s_waitcnt vmcnt(16)
  v_and_b32 v32, v8, v56
  v_and_b32 v33, v9, v56
  v_and_b32 v34, v10, v56
  v_and_b32 v35, v11, v56
  s_nop 1
  v_mfma_f32_16x16x32_bf16 v[20:23], v[32:35], v[224:227], v[20:23]
  v_mfma_f32_16x16x32_bf16 v[24:27], v[32:35], v[228:231], v[24:27]
  v_and_b32 v36, v8, v57
  v_and_b32 v37, v9, v57
  v_and_b32 v38, v10, v57
  v_and_b32 v39, v11, v57
  s_nop 1
  v_mfma_f32_16x16x32_bf16 v[20:23], v[36:39], v[232:235], v[20:23]
  v_mfma_f32_16x16x32_bf16 v[24:27], v[36:39], v[236:239], v[24:27]
  v_and_b32 v32, v8, v58
  v_and_b32 v33, v9, v58
  v_and_b32 v34, v10, v58
  v_and_b32 v35, v11, v58
  s_nop 1
  v_mfma_f32_16x16x32_bf16 v[20:23], v[32:35], v[240:243], v[20:23]
  v_mfma_f32_16x16x32_bf16 v[24:27], v[32:35], v[244:247], v[24:27]
  v_and_b32 v36, v8, v59
  v_and_b32 v37, v9, v59
  v_and_b32 v38, v10, v59
  v_and_b32 v39, v11, v59
  s_nop 1
  v_mfma_f32_16x16x32_bf16 v[20:23], v[36:39], v[248:251], v[20:23]
  v_mfma_f32_16x16x32_bf16 v[24:27], v[36:39], v[252:255], v[24:27]
L_loop:
  s_mov_b64 exec, 1
  ds_add_rtn_u32 v31, v60, v61
  s_mov_b64 exec, -1
  s_waitcnt vmcnt(8)
  v_mfma_f32_16x16x32_bf16 v[32:35], v[64:67], v[12:15], 0
  v_mfma_f32_16x16x32_bf16 v[36:39], v[72:75], v[12:15], 0
  v_mfma_f32_16x16x32_bf16 v[40:43], v[80:83], v[12:15], 0
  v_mfma_f32_16x16x32_bf16 v[44:47], v[88:91], v[12:15], 0
  v_mfma_f32_16x16x32_bf16 v[32:35], v[68:71], v[16:19], v[32:35]
  v_mfma_f32_16x16x32_bf16 v[36:39], v[76:79], v[16:19], v[36:39]
  v_mfma_f32_16x16x32_bf16 v[40:43], v[84:87], v[16:19], v[40:43]
  v_mfma_f32_16x16x32_bf16 v[44:47], v[92:95], v[16:19], v[44:47]
  s_waitcnt lgkmcnt(0)
  s_mov_b64 exec, 1
  v_lshlrev_b32 v62, 2, v31
L_spin_14:
  ds_read_b32 v31, v62 offset:64
  s_waitcnt lgkmcnt(0)
  v_readfirstlane_b32 s66, v31
  s_nop 1
  s_cmp_eq_u32 s66, -1
  s_cbranch_scc1 L_spin_14
  s_mov_b64 exec, -1
  s_cmp_ge_u32 s66, 4096
  s_cbranch_scc1 L_drain_13
  s_lshr_b32 s72, s66, 0
  s_mul_i32 s72, s72, 8192
  s_and_b32 s73, s66, 0
  s_lshl_b32 s73, s73, 11
  s_add_u32 s72, s72, s73
  s_add_u32 s73, s72, 2048
  s_add_u32 s74, s72, 4096
  s_add_u32 s75, s72, 6144
  buffer_load_dwordx4 v[64:67], v4, s[8:11], s72 offen offset:0 nt
  buffer_load_dwordx4 v[68:71], v4, s[8:11], s72 offen offset:256 nt
  buffer_load_dwordx4 v[72:75], v4, s[8:11], s73 offen offset:0 nt
  buffer_load_dwordx4 v[76:79], v4, s[8:11], s73 offen offset:256 nt
  buffer_load_dwordx4 v[80:83], v4, s[8:11], s74 offen offset:0 nt
  buffer_load_dwordx4 v[84:87], v4, s[8:11], s74 offen offset:256 nt
  buffer_load_dwordx4 v[88:91], v4, s[8:11], s75 offen offset:0 nt
  buffer_load_dwordx4 v[92:95], v4, s[8:11], s75 offen offset:256 nt
  v_mov_b32_dpp v48, v32 quad_perm:[0,0,0,0] row_mask:0xf bank_mask:0xf
  v_mov_b32_dpp v49, v36 quad_perm:[0,0,0,0] row_mask:0xf bank_mask:0xf
  v_mov_b32_dpp v50, v40 quad_perm:[0,0,0,0] row_mask:0xf bank_mask:0xf
  v_mov_b32_dpp v51, v44 quad_perm:[0,0,0,0] row_mask:0xf bank_mask:0xf
  v_add_f32_dpp v48, v33, v48 quad_perm:[1,1,1,1] row_mask:0xf bank_mask:0xf
  v_add_f32_dpp v49, v37, v49 quad_perm:[1,1,1,1] row_mask:0xf bank_mask:0xf
  v_add_f32_dpp v50, v41, v50 quad_perm:[1,1,1,1] row_mask:0xf bank_mask:0xf
  v_add_f32_dpp v51, v45, v51 quad_perm:[1,1,1,1] row_mask:0xf bank_mask:0xf
  v_add_f32_dpp v48, v34, v48 quad_perm:[2,2,2,2] row_mask:0xf bank_mask:0xf
  v_add_f32_dpp v49, v38, v49 quad_perm:[2,2,2,2] row_mask:0xf bank_mask:0xf
  v_add_f32_dpp v50, v42, v50 quad_perm:[2,2,2,2] row_mask:0xf bank_mask:0xf
  v_add_f32_dpp v51, v46, v51 quad_perm:[2,2,2,2] row_mask:0xf bank_mask:0xf
  v_add_f32_dpp v48, v35, v48 quad_perm:[3,3,3,3] row_mask:0xf bank_mask:0xf
  v_add_f32_dpp v49, v39, v49 quad_perm:[3,3,3,3] row_mask:0xf bank_mask:0xf
  v_add_f32_dpp v50, v43, v50 quad_perm:[3,3,3,3] row_mask:0xf bank_mask:0xf
  v_add_f32_dpp v51, v47, v51 quad_perm:[3,3,3,3] row_mask:0xf bank_mask:0xf
  v_cvt_pk_bf16_f32 v52, v48, v49
  v_cvt_pk_bf16_f32 v53, v50, v51
  v_lshlrev_b32 v48, 16, v52
  v_and_b32 v49, 0xffff0000, v52
  v_lshlrev_b32 v50, 16, v53
  v_and_b32 v51, 0xffff0000, v53
  v_max3_f32 v52, v48, v49, v50
  v_max_f32 v52, v52, v51
  v_cmp_gt_f32 vcc, v52, v28
  s_nop 0
  s_cbranch_vccnz L_rare_15
L_back_16:
  v_fma_f32 v52, v48, s60, -v29
  v_fma_f32 v53, v49, s60, -v29
  v_fma_f32 v54, v50, s60, -v29
  v_fma_f32 v55, v51, s60, -v29
  v_exp_f32 v52, v52
  v_exp_f32 v53, v53
  v_exp_f32 v54, v54
  v_exp_f32 v55, v55
  s_nop 0
  v_cvt_pk_bf16_f32 v56, v52, v52
  v_cvt_pk_bf16_f32 v57, v53, v53
  v_cvt_pk_bf16_f32 v58, v54, v54
  v_cvt_pk_bf16_f32 v59, v55, v55
  v_add_f32 v52, v52, v53
  v_add_f32 v54, v54, v55
  v_add_f32 v30, v30, v52
  v_add_f32 v30, v30, v54
  s_waitcnt vmcnt(8)
  v_and_b32 v32, v8, v56
  v_and_b32 v33, v9, v56
  v_and_b32 v34, v10, v56
  v_and_b32 v35, v11, v56
  s_nop 1
  v_mfma_f32_16x16x32_bf16 v[20:23], v[32:35], v[96:99], v[20:23]
  v_mfma_f32_16x16x32_bf16 v[24:27], v[32:35], v[100:103], v[24:27]
  v_and_b32 v36, v8, v57
  v_and_b32 v37, v9, v57
  v_and_b32 v38, v10, v57
  v_and_b32 v39, v11, v57
  s_nop 1
  v_mfma_f32_16x16x32_bf16 v[20:23], v[36:39], v[104:107], v[20:23]
  v_mfma_f32_16x16x32_bf16 v[24:27], v[36:39], v[108:111], v[24:27]
  v_and_b32 v32, v8, v58
  v_and_b32 v33, v9, v58
  v_and_b32 v34, v10, v58
  v_and_b32 v35, v11, v58
  s_nop 1
  v_mfma_f32_16x16x32_bf16 v[20:23], v[32:35], v[112:115], v[20:23]
  v_mfma_f32_16x16x32_bf16 v[24:27], v[32:35], v[116:119], v[24:27]
  v_and_b32 v36, v8, v59
  v_and_b32 v37, v9, v59
  v_and_b32 v38, v10, v59
  v_and_b32 v39, v11, v59
  s_nop 1
  v_mfma_f32_16x16x32_bf16 v[20:23], v[36:39], v[120:123], v[20:23]
  v_mfma_f32_16x16x32_bf16 v[24:27], v[36:39], v[124:127], v[24:27]
  buffer_load_dwordx4 v[96:99], v6, s[12:15], s72 offen offset:0 nt
  buffer_load_dwordx4 v[100:103], v6, s[12:15], s72 offen offset:256 nt
  buffer_load_dwordx4 v[104:107], v6, s[12:15], s73 offen offset:0 nt
  buffer_load_dwordx4 v[108:111], v6, s[12:15], s73 offen offset:256 nt
  buffer_load_dwordx4 v[112:115], v6, s[12:15], s74 offen offset:0 nt
  buffer_load_dwordx4 v[116:119], v6, s[12:15], s74 offen offset:256 nt
  buffer_load_dwordx4 v[120:123], v6, s[12:15], s75 offen offset:0 nt
  buffer_load_dwordx4 v[124:127], v6, s[12:15], s75 offen offset:256 nt
  s_branch L_loop
L_drain_5:
  s_nop 7
  v_mov_b32_dpp v48, v32 quad_perm:[0,0,0,0] row_mask:0xf bank_mask:0xf
  v_mov_b32_dpp v49, v36 quad_perm:[0,0,0,0] row_mask:0xf bank_mask:0xf
  v_mov_b32_dpp v50, v40 quad_perm:[0,0,0,0] row_mask:0xf bank_mask:0xf
  v_mov_b32_dpp v51, v44 quad_perm:[0,0,0,0] row_mask:0xf bank_mask:0xf
  v_add_f32_dpp v48, v33, v48 quad_perm:[1,1,1,1] row_mask:0xf bank_mask:0xf
  v_add_f32_dpp v49, v37, v49 quad_perm:[1,1,1,1] row_mask:0xf bank_mask:0xf
  v_add_f32_dpp v50, v41, v50 quad_perm:[1,1,1,1] row_mask:0xf bank_mask:0xf
  v_add_f32_dpp v51, v45, v51 quad_perm:[1,1,1,1] row_mask:0xf bank_mask:0xf
  v_add_f32_dpp v48, v34, v48 quad_perm:[2,2,2,2] row_mask:0xf bank_mask:0xf
  v_add_f32_dpp v49, v38, v49 quad_perm:[2,2,2,2] row_mask:0xf bank_mask:0xf
  v_add_f32_dpp v50, v42, v50 quad_perm:[2,2,2,2] row_mask:0xf bank_mask:0xf
  v_add_f32_dpp v51, v46, v51 quad_perm:[2,2,2,2] row_mask:0xf bank_mask:0xf
  v_add_f32_dpp v48, v35, v48 quad_perm:[3,3,3,3] row_mask:0xf bank_mask:0xf
  v_add_f32_dpp v49, v39, v49 quad_perm:[3,3,3,3] row_mask:0xf bank_mask:0xf
  v_add_f32_dpp v50, v43, v50 quad_perm:[3,3,3,3] row_mask:0xf bank_mask:0xf
  v_add_f32_dpp v51, v47, v51 quad_perm:[3,3,3,3] row_mask:0xf bank_mask:0xf
  v_cvt_pk_bf16_f32 v52, v48, v49
  v_cvt_pk_bf16_f32 v53, v50, v51
  v_lshlrev_b32 v48, 16, v52
  v_and_b32 v49, 0xffff0000, v52
  v_lshlrev_b32 v50, 16, v53
  v_and_b32 v51, 0xffff0000, v53
  v_max3_f32 v52, v48, v49, v50
  v_max_f32 v52, v52, v51
  v_cmp_gt_f32 vcc, v52, v28
  s_nop 0
  s_cbranch_vccnz L_rare_17
L_back_18:
  v_fma_f32 v52, v48, s60, -v29
  v_fma_f32 v53, v49, s60, -v29
  v_fma_f32 v54, v50, s60, -v29
  v_fma_f32 v55, v51, s60, -v29
  v_exp_f32 v52, v52
  v_exp_f32 v53, v53
  v_exp_f32 v54, v54
  v_exp_f32 v55, v55
  s_nop 0
  v_cvt_pk_bf16_f32 v56, v52, v52
  v_cvt_pk_bf16_f32 v57, v53, v53
  v_cvt_pk_bf16_f32 v58, v54, v54
  v_cvt_pk_bf16_f32 v59, v55, v55
  v_add_f32 v52, v52, v53
  v_add_f32 v54, v54, v55
  v_add_f32 v30, v30, v52
  v_add_f32 v30, v30, v54
  v_and_b32 v32, v8, v56
  v_and_b32 v33, v9, v56
  v_and_b32 v34, v10, v56
  v_and_b32 v35, v11, v56
  s_nop 1
  v_mfma_f32_16x16x32_bf16 v[20:23], v[32:35], v[96:99], v[20:23]
  v_mfma_f32_16x16x32_bf16 v[24:27], v[32:35], v[100:103], v[24:27]
  v_and_b32 v36, v8, v57
  v_and_b32 v37, v9, v57
  v_and_b32 v38, v10, v57
  v_and_b32 v39, v11, v57
  s_nop 1
  v_mfma_f32_16x16x32_bf16 v[20:23], v[36:39], v[104:107], v[20:23]
  v_mfma_f32_16x16x32_bf16 v[24:27], v[36:39], v[108:111], v[24:27]
  v_and_b32 v32, v8, v58
  v_and_b32 v33, v9, v58
  v_and_b32 v34, v10, v58
  v_and_b32 v35, v11, v58
  s_nop 1
  v_mfma_f32_16x16x32_bf16 v[20:23], v[32:35], v[112:115], v[20:23]
  v_mfma_f32_16x16x32_bf16 v[24:27], v[32:35], v[116:119], v[24:27]
  v_and_b32 v36, v8, v59
  v_and_b32 v37, v9, v59
  v_and_b32 v38, v10, v59
  v_and_b32 v39, v11, v59
  s_nop 1
  v_mfma_f32_16x16x32_bf16 v[20:23], v[36:39], v[120:123], v[20:23]
  v_mfma_f32_16x16x32_bf16 v[24:27], v[36:39], v[124:127], v[24:27]
  v_mfma_f32_16x16x32_bf16 v[32:35], v[128:131], v[12:15], 0
  v_mfma_f32_16x16x32_bf16 v[36:39], v[136:139], v[12:15], 0
  v_mfma_f32_16x16x32_bf16 v[40:43], v[144:147], v[12:15], 0
  v_mfma_f32_16x16x32_bf16 v[44:47], v[152:155], v[12:15], 0
  v_mfma_f32_16x16x32_bf16 v[32:35], v[132:135], v[16:19], v[32:35]
  v_mfma_f32_16x16x32_bf16 v[36:39], v[140:143], v[16:19], v[36:39]
  v_mfma_f32_16x16x32_bf16 v[40:43], v[148:151], v[16:19], v[40:43]
  v_mfma_f32_16x16x32_bf16 v[44:47], v[156:159], v[16:19], v[44:47]
  s_nop 7
  v_mov_b32_dpp v48, v32 quad_perm:[0,0,0,0] row_mask:0xf bank_mask:0xf
  v_mov_b32_dpp v49, v36 quad_perm:[0,0,0,0] row_mask:0xf bank_mask:0xf
  v_mov_b32_dpp v50, v40 quad_perm:[0,0,0,0] row_mask:0xf bank_mask:0xf
  v_mov_b32_dpp v51, v44 quad_perm:[0,0,0,0] row_mask:0xf bank_mask:0xf
  v_add_f32_dpp v48, v33, v48 quad_perm:[1,1,1,1] row_mask:0xf bank_mask:0xf
  v_add_f32_dpp v49, v37, v49 quad_perm:[1,1,1,1] row_mask:0xf bank_mask:0xf
  v_add_f32_dpp v50, v41, v50 quad_perm:[1,1,1,1] row_mask:0xf bank_mask:0xf
  v_add_f32_dpp v51, v45, v51 quad_perm:[1,1,1,1] row_mask:0xf bank_mask:0xf
  v_add_f32_dpp v48, v34, v48 quad_perm:[2,2,2,2] row_mask:0xf bank_mask:0xf
  v_add_f32_dpp v49, v38, v49 quad_perm:[2,2,2,2] row_mask:0xf bank_mask:0xf
  v_add_f32_dpp v50, v42, v50 quad_perm:[2,2,2,2] row_mask:0xf bank_mask:0xf
  v_add_f32_dpp v51, v46, v51 quad_perm:[2,2,2,2] row_mask:0xf bank_mask:0xf
  v_add_f32_dpp v48, v35, v48 quad_perm:[3,3,3,3] row_mask:0xf bank_mask:0xf
  v_add_f32_dpp v49, v39, v49 quad_perm:[3,3,3,3] row_mask:0xf bank_mask:0xf
  v_add_f32_dpp v50, v43, v50 quad_perm:[3,3,3,3] row_mask:0xf bank_mask:0xf
  v_add_f32_dpp v51, v47, v51 quad_perm:[3,3,3,3] row_mask:0xf bank_mask:0xf
  v_cvt_pk_bf16_f32 v52, v48, v49
  v_cvt_pk_bf16_f32 v53, v50, v51
  v_lshlrev_b32 v48, 16, v52
  v_and_b32 v49, 0xffff0000, v52
  v_lshlrev_b32 v50, 16, v53
  v_and_b32 v51, 0xffff0000, v53
  v_max3_f32 v52, v48, v49, v50
  v_max_f32 v52, v52, v51
  v_cmp_gt_f32 vcc, v52, v28
  s_nop 0
  s_cbranch_vccnz L_rare_19
L_back_20:
  v_fma_f32 v52, v48, s60, -v29
  v_fma_f32 v53, v49, s60, -v29
  v_fma_f32 v54, v50, s60, -v29
  v_fma_f32 v55, v51, s60, -v29
  v_exp_f32 v52, v52
  v_exp_f32 v53, v53
  v_exp_f32 v54, v54
  v_exp_f32 v55, v55
  s_nop 0
  v_cvt_pk_bf16_f32 v56, v52, v52
  v_cvt_pk_bf16_f32 v57, v53, v53
  v_cvt_pk_bf16_f32 v58, v54, v54
  v_cvt_pk_bf16_f32 v59, v55, v55
  v_add_f32 v52, v52, v53
  v_add_f32 v54, v54, v55
  v_add_f32 v30, v30, v52
  v_add_f32 v30, v30, v54
  v_and_b32 v32, v8, v56
  v_and_b32 v33, v9, v56
  v_and_b32 v34, v10, v56
  v_and_b32 v35, v11, v56
  s_nop 1
  v_mfma_f32_16x16x32_bf16 v[20:23], v[32:35], v[160:163], v[20:23]
  v_mfma_f32_16x16x32_bf16 v[24:27], v[32:35], v[164:167], v[24:27]
  v_and_b32 v36, v8, v57
  v_and_b32 v37, v9, v57
  v_and_b32 v38, v10, v57
  v_and_b32 v39, v11, v57
  s_nop 1
  v_mfma_f32_16x16x32_bf16 v[20:23], v[36:39], v[168:171], v[20:23]
  v_mfma_f32_16x16x32_bf16 v[24:27], v[36:39], v[172:175], v[24:27]
  v_and_b32 v32, v8, v58
  v_and_b32 v33, v9, v58
  v_and_b32 v34, v10, v58
  v_and_b32 v35, v11, v58
  s_nop 1
  v_mfma_f32_16x16x32_bf16 v[20:23], v[32:35], v[176:179], v[20:23]
  v_mfma_f32_16x16x32_bf16 v[24:27], v[32:35], v[180:183], v[24:27]
  v_and_b32 v36, v8, v59
  v_and_b32 v37, v9, v59
  v_and_b32 v38, v10, v59
  v_and_b32 v39, v11, v59
  s_nop 1
  v_mfma_f32_16x16x32_bf16 v[20:23], v[36:39], v[184:187], v[20:23]
  v_mfma_f32_16x16x32_bf16 v[24:27], v[36:39], v[188:191], v[24:27]
  v_mfma_f32_16x16x32_bf16 v[32:35], v[192:195], v[12:15], 0
  v_mfma_f32_16x16x32_bf16 v[36:39], v[200:203], v[12:15], 0
  v_mfma_f32_16x16x32_bf16 v[40:43], v[208:211], v[12:15], 0
  v_mfma_f32_16x16x32_bf16 v[44:47], v[216:219], v[12:15], 0
  v_mfma_f32_16x16x32_bf16 v[32:35], v[196:199], v[16:19], v[32:35]
  v_mfma_f32_16x16x32_bf16 v[36:39], v[204:207], v[16:19], v[36:39]
  v_mfma_f32_16x16x32_bf16 v[40:43], v[212:215], v[16:19], v[40:43]
  v_mfma_f32_16x16x32_bf16 v[44:47], v[220:223], v[16:19], v[44:47]
  s_nop 7
  v_mov_b32_dpp v48, v32 quad_perm:[0,0,0,0] row_mask:0xf bank_mask:0xf
  v_mov_b32_dpp v49, v36 quad_perm:[0,0,0,0] row_mask:0xf bank_mask:0xf
  v_mov_b32_dpp v50, v40 quad_perm:[0,0,0,0] row_mask:0xf bank_mask:0xf
  v_mov_b32_dpp v51, v44 quad_perm:[0,0,0,0] row_mask:0xf bank_mask:0xf
  v_add_f32_dpp v48, v33, v48 quad_perm:[1,1,1,1] row_mask:0xf bank_mask:0xf
  v_add_f32_dpp v49, v37, v49 quad_perm:[1,1,1,1] row_mask:0xf bank_mask:0xf
  v_add_f32_dpp v50, v41, v50 quad_perm:[1,1,1,1] row_mask:0xf bank_mask:0xf
  v_add_f32_dpp v51, v45, v51 quad_perm:[1,1,1,1] row_mask:0xf bank_mask:0xf
  v_add_f32_dpp v48, v34, v48 quad_perm:[2,2,2,2] row_mask:0xf bank_mask:0xf
  v_add_f32_dpp v49, v38, v49 quad_perm:[2,2,2,2] row_mask:0xf bank_mask:0xf
  v_add_f32_dpp v50, v42, v50 quad_perm:[2,2,2,2] row_mask:0xf bank_mask:0xf
  v_add_f32_dpp v51, v46, v51 quad_perm:[2,2,2,2] row_mask:0xf bank_mask:0xf
  v_add_f32_dpp v48, v35, v48 quad_perm:[3,3,3,3] row_mask:0xf bank_mask:0xf
  v_add_f32_dpp v49, v39, v49 quad_perm:[3,3,3,3] row_mask:0xf bank_mask:0xf
  v_add_f32_dpp v50, v43, v50 quad_perm:[3,3,3,3] row_mask:0xf bank_mask:0xf
  v_add_f32_dpp v51, v47, v51 quad_perm:[3,3,3,3] row_mask:0xf bank_mask:0xf
  v_cvt_pk_bf16_f32 v52, v48, v49
  v_cvt_pk_bf16_f32 v53, v50, v51
  v_lshlrev_b32 v48, 16, v52
  v_and_b32 v49, 0xffff0000, v52
  v_lshlrev_b32 v50, 16, v53
  v_and_b32 v51, 0xffff0000, v53
  v_max3_f32 v52, v48, v49, v50
  v_max_f32 v52, v52, v51
  v_cmp_gt_f32 vcc, v52, v28
  s_nop 0
  s_cbranch_vccnz L_rare_21
L_back_22:
  v_fma_f32 v52, v48, s60, -v29
  v_fma_f32 v53, v49, s60, -v29
  v_fma_f32 v54, v50, s60, -v29
  v_fma_f32 v55, v51, s60, -v29
  v_exp_f32 v52, v52
  v_exp_f32 v53, v53
  v_exp_f32 v54, v54
  v_exp_f32 v55, v55
  s_nop 0
  v_cvt_pk_bf16_f32 v56, v52, v52
  v_cvt_pk_bf16_f32 v57, v53, v53
  v_cvt_pk_bf16_f32 v58, v54, v54
  v_cvt_pk_bf16_f32 v59, v55, v55
  v_add_f32 v52, v52, v53
  v_add_f32 v54, v54, v55
  v_add_f32 v30, v30, v52
  v_add_f32 v30, v30, v54
  s_waitcnt vmcnt(0)
  v_and_b32 v32, v8, v56
  v_and_b32 v33, v9, v56
  v_and_b32 v34, v10, v56
  v_and_b32 v35, v11, v56
  s_nop 1
  v_mfma_f32_16x16x32_bf16 v[20:23], v[32:35], v[224:227], v[20:23]
  v_mfma_f32_16x16x32_bf16 v[24:27], v[32:35], v[228:231], v[24:27]
  v_and_b32 v36, v8, v57
  v_and_b32 v37, v9, v57
  v_and_b32 v38, v10, v57
  v_and_b32 v39, v11, v57
  s_nop 1
  v_mfma_f32_16x16x32_bf16 v[20:23], v[36:39], v[232:235], v[20:23]
  v_mfma_f32_16x16x32_bf16 v[24:27], v[36:39], v[236:239], v[24:27]
  v_and_b32 v32, v8, v58
  v_and_b32 v33, v9, v58
  v_and_b32 v34, v10, v58
  v_and_b32 v35, v11, v58
  s_nop 1
  v_mfma_f32_16x16x32_bf16 v[20:23], v[32:35], v[240:243], v[20:23]
  v_mfma_f32_16x16x32_bf16 v[24:27], v[32:35], v[244:247], v[24:27]
  v_and_b32 v36, v8, v59
  v_and_b32 v37, v9, v59
  v_and_b32 v38, v10, v59
  v_and_b32 v39, v11, v59
  s_nop 1
  v_mfma_f32_16x16x32_bf16 v[20:23], v[36:39], v[248:251], v[20:23]
  v_mfma_f32_16x16x32_bf16 v[24:27], v[36:39], v[252:255], v[24:27]
  s_branch L_wfin
L_drain_13:
  s_nop 7
  v_mov_b32_dpp v48, v32 quad_perm:[0,0,0,0] row_mask:0xf bank_mask:0xf
  v_mov_b32_dpp v49, v36 quad_perm:[0,0,0,0] row_mask:0xf bank_mask:0xf
  v_mov_b32_dpp v50, v40 quad_perm:[0,0,0,0] row_mask:0xf bank_mask:0xf
  v_mov_b32_dpp v51, v44 quad_perm:[0,0,0,0] row_mask:0xf bank_mask:0xf
  v_add_f32_dpp v48, v33, v48 quad_perm:[1,1,1,1] row_mask:0xf bank_mask:0xf
  v_add_f32_dpp v49, v37, v49 quad_perm:[1,1,1,1] row_mask:0xf bank_mask:0xf
  v_add_f32_dpp v50, v41, v50 quad_perm:[1,1,1,1] row_mask:0xf bank_mask:0xf
  v_add_f32_dpp v51, v45, v51 quad_perm:[1,1,1,1] row_mask:0xf bank_mask:0xf
  v_add_f32_dpp v48, v34, v48 quad_perm:[2,2,2,2] row_mask:0xf bank_mask:0xf
  v_add_f32_dpp v49, v38, v49 quad_perm:[2,2,2,2] row_mask:0xf bank_mask:0xf
  v_add_f32_dpp v50, v42, v50 quad_perm:[2,2,2,2] row_mask:0xf bank_mask:0xf
  v_add_f32_dpp v51, v46, v51 quad_perm:[2,2,2,2] row_mask:0xf bank_mask:0xf
  v_add_f32_dpp v48, v35, v48 quad_perm:[3,3,3,3] row_mask:0xf bank_mask:0xf
  v_add_f32_dpp v49, v39, v49 quad_perm:[3,3,3,3] row_mask:0xf bank_mask:0xf
  v_add_f32_dpp v50, v43, v50 quad_perm:[3,3,3,3] row_mask:0xf bank_mask:0xf
  v_add_f32_dpp v51, v47, v51 quad_perm:[3,3,3,3] row_mask:0xf bank_mask:0xf
  v_cvt_pk_bf16_f32 v52, v48, v49
  v_cvt_pk_bf16_f32 v53, v50, v51
  v_lshlrev_b32 v48, 16, v52
  v_and_b32 v49, 0xffff0000, v52
  v_lshlrev_b32 v50, 16, v53
  v_and_b32 v51, 0xffff0000, v53
  v_max3_f32 v52, v48, v49, v50
  v_max_f32 v52, v52, v51
  v_cmp_gt_f32 vcc, v52, v28
  s_nop 0
  s_cbranch_vccnz L_rare_23
L_back_24:
  v_fma_f32 v52, v48, s60, -v29
  v_fma_f32 v53, v49, s60, -v29
  v_fma_f32 v54, v50, s60, -v29
  v_fma_f32 v55, v51, s60, -v29
  v_exp_f32 v52, v52
  v_exp_f32 v53, v53
  v_exp_f32 v54, v54
  v_exp_f32 v55, v55
  s_nop 0
  v_cvt_pk_bf16_f32 v56, v52, v52
  v_cvt_pk_bf16_f32 v57, v53, v53
  v_cvt_pk_bf16_f32 v58, v54, v54
  v_cvt_pk_bf16_f32 v59, v55, v55
  v_add_f32 v52, v52, v53
  v_add_f32 v54, v54, v55
  v_add_f32 v30, v30, v52
  v_add_f32 v30, v30, v54
  s_waitcnt vmcnt(0)
  v_and_b32 v32, v8, v56
  v_and_b32 v33, v9, v56
  v_and_b32 v34, v10, v56
  v_and_b32 v35, v11, v56
  s_nop 1
  v_mfma_f32_16x16x32_bf16 v[20:23], v[32:35], v[96:99], v[20:23]
  v_mfma_f32_16x16x32_bf16 v[24:27], v[32:35], v[100:103], v[24:27]
  v_and_b32 v36, v8, v57
  v_and_b32 v37, v9, v57
  v_and_b32 v38, v10, v57
  v_and_b32 v39, v11, v57
  s_nop 1
  v_mfma_f32_16x16x32_bf16 v[20:23], v[36:39], v[104:107], v[20:23]
  v_mfma_f32_16x16x32_bf16 v[24:27], v[36:39], v[108:111], v[24:27]
  v_and_b32 v32, v8, v58
  v_and_b32 v33, v9, v58
  v_and_b32 v34, v10, v58
  v_and_b32 v35, v11, v58
  s_nop 1
  v_mfma_f32_16x16x32_bf16 v[20:23], v[32:35], v[112:115], v[20:23]
  v_mfma_f32_16x16x32_bf16 v[24:27], v[32:35], v[116:119], v[24:27]
  v_and_b32 v36, v8, v59
  v_and_b32 v37, v9, v59
  v_and_b32 v38, v10, v59
  v_and_b32 v39, v11, v59
  s_nop 1
  v_mfma_f32_16x16x32_bf16 v[20:23], v[36:39], v[120:123], v[20:23]
  v_mfma_f32_16x16x32_bf16 v[24:27], v[36:39], v[124:127], v[24:27]
  s_branch L_wfin
L_static_only:
  v_mfma_f32_16x16x32_bf16 v[32:35], v[64:67], v[12:15], 0
  v_mfma_f32_16x16x32_bf16 v[36:39], v[72:75], v[12:15], 0
  v_mfma_f32_16x16x32_bf16 v[40:43], v[80:83], v[12:15], 0
  v_mfma_f32_16x16x32_bf16 v[44:47], v[88:91], v[12:15], 0
  v_mfma_f32_16x16x32_bf16 v[32:35], v[68:71], v[16:19], v[32:35]
  v_mfma_f32_16x16x32_bf16 v[36:39], v[76:79], v[16:19], v[36:39]
  v_mfma_f32_16x16x32_bf16 v[40:43], v[84:87], v[16:19], v[40:43]
  v_mfma_f32_16x16x32_bf16 v[44:47], v[92:95], v[16:19], v[44:47]
  s_nop 7
  v_mov_b32_dpp v48, v32 quad_perm:[0,0,0,0] row_mask:0xf bank_mask:0xf
  v_mov_b32_dpp v49, v36 quad_perm:[0,0,0,0] row_mask:0xf bank_mask:0xf
  v_mov_b32_dpp v50, v40 quad_perm:[0,0,0,0] row_mask:0xf bank_mask:0xf
  v_mov_b32_dpp v51, v44 quad_perm:[0,0,0,0] row_mask:0xf bank_mask:0xf
  v_add_f32_dpp v48, v33, v48 quad_perm:[1,1,1,1] row_mask:0xf bank_mask:0xf
  v_add_f32_dpp v49, v37, v49 quad_perm:[1,1,1,1] row_mask:0xf bank_mask:0xf
  v_add_f32_dpp v50, v41, v50 quad_perm:[1,1,1,1] row_mask:0xf bank_mask:0xf
  v_add_f32_dpp v51, v45, v51 quad_perm:[1,1,1,1] row_mask:0xf bank_mask:0xf
  v_add_f32_dpp v48, v34, v48 quad_perm:[2,2,2,2] row_mask:0xf bank_mask:0xf
  v_add_f32_dpp v49, v38, v49 quad_perm:[2,2,2,2] row_mask:0xf bank_mask:0xf
  v_add_f32_dpp v50, v42, v50 quad_perm:[2,2,2,2] row_mask:0xf bank_mask:0xf
  v_add_f32_dpp v51, v46, v51 quad_perm:[2,2,2,2] row_mask:0xf bank_mask:0xf
  v_add_f32_dpp v48, v35, v48 quad_perm:[3,3,3,3] row_mask:0xf bank_mask:0xf
  v_add_f32_dpp v49, v39, v49 quad_perm:[3,3,3,3] row_mask:0xf bank_mask:0xf
  v_add_f32_dpp v50, v43, v50 quad_perm:[3,3,3,3] row_mask:0xf bank_mask:0xf
  v_add_f32_dpp v51, v47, v51 quad_perm:[3,3,3,3] row_mask:0xf bank_mask:0xf
  v_cvt_pk_bf16_f32 v52, v48, v49
  v_cvt_pk_bf16_f32 v53, v50, v51
  v_lshlrev_b32 v48, 16, v52
  v_and_b32 v49, 0xffff0000, v52
  v_lshlrev_b32 v50, 16, v53
  v_and_b32 v51, 0xffff0000, v53
  v_max3_f32 v52, v48, v49, v50
  v_max_f32 v52, v52, v51
  v_cmp_gt_f32 vcc, v52, v28
  s_nop 0
  s_cbranch_vccnz L_rare_25
L_back_26:
  v_fma_f32 v52, v48, s60, -v29
  v_fma_f32 v53, v49, s60, -v29
  v_fma_f32 v54, v50, s60, -v29
  v_fma_f32 v55, v51, s60, -v29
  v_exp_f32 v52, v52
  v_exp_f32 v53, v53
  v_exp_f32 v54, v54
  v_exp_f32 v55, v55
  s_nop 0
  v_cvt_pk_bf16_f32 v56, v52, v52
  v_cvt_pk_bf16_f32 v57, v53, v53
  v_cvt_pk_bf16_f32 v58, v54, v54
  v_cvt_pk_bf16_f32 v59, v55, v55
  v_add_f32 v52, v52, v53
  v_add_f32 v54, v54, v55
  v_add_f32 v30, v30, v52
  v_add_f32 v30, v30, v54
  v_and_b32 v32, v8, v56
  v_and_b32 v33, v9, v56
  v_and_b32 v34, v10, v56
  v_and_b32 v35, v11, v56
  s_nop 1
  v_mfma_f32_16x16x32_bf16 v[20:23], v[32:35], v[96:99], v[20:23]
  v_mfma_f32_16x16x32_bf16 v[24:27], v[32:35], v[100:103], v[24:27]
  v_and_b32 v36, v8, v57
  v_and_b32 v37, v9, v57
  v_and_b32 v38, v10, v57
  v_and_b32 v39, v11, v57
  s_nop 1
  v_mfma_f32_16x16x32_bf16 v[20:23], v[36:39], v[104:107], v[20:23]
  v_mfma_f32_16x16x32_bf16 v[24:27], v[36:39], v[108:111], v[24:27]
  v_and_b32 v32, v8, v58
  v_and_b32 v33, v9, v58
  v_and_b32 v34, v10, v58
  v_and_b32 v35, v11, v58
  s_nop 1
  v_mfma_f32_16x16x32_bf16 v[20:23], v[32:35], v[112:115], v[20:23]
  v_mfma_f32_16x16x32_bf16 v[24:27], v[32:35], v[116:119], v[24:27]
  v_and_b32 v36, v8, v59
  v_and_b32 v37, v9, v59
  v_and_b32 v38, v10, v59
  v_and_b32 v39, v11, v59
  s_nop 1
  v_mfma_f32_16x16x32_bf16 v[20:23], v[36:39], v[120:123], v[20:23]
  v_mfma_f32_16x16x32_bf16 v[24:27], v[36:39], v[124:127], v[24:27]
  v_mfma_f32_16x16x32_bf16 v[32:35], v[128:131], v[12:15], 0
  v_mfma_f32_16x16x32_bf16 v[36:39], v[136:139], v[12:15], 0
  v_mfma_f32_16x16x32_bf16 v[40:43], v[144:147], v[12:15], 0
  v_mfma_f32_16x16x32_bf16 v[44:47], v[152:155], v[12:15], 0
  v_mfma_f32_16x16x32_bf16 v[32:35], v[132:135], v[16:19], v[32:35]
  v_mfma_f32_16x16x32_bf16 v[36:39], v[140:143], v[16:19], v[36:39]
  v_mfma_f32_16x16x32_bf16 v[40:43], v[148:151], v[16:19], v[40:43]
  v_mfma_f32_16x16x32_bf16 v[44:47], v[156:159], v[16:19], v[44:47]
  s_nop 7
  v_mov_b32_dpp v48, v32 quad_perm:[0,0,0,0] row_mask:0xf bank_mask:0xf
  v_mov_b32_dpp v49, v36 quad_perm:[0,0,0,0] row_mask:0xf bank_mask:0xf
  v_mov_b32_dpp v50, v40 quad_perm:[0,0,0,0] row_mask:0xf bank_mask:0xf
  v_mov_b32_dpp v51, v44 quad_perm:[0,0,0,0] row_mask:0xf bank_mask:0xf
  v_add_f32_dpp v48, v33, v48 quad_perm:[1,1,1,1] row_mask:0xf bank_mask:0xf
  v_add_f32_dpp v49, v37, v49 quad_perm:[1,1,1,1] row_mask:0xf bank_mask:0xf
  v_add_f32_dpp v50, v41, v50 quad_perm:[1,1,1,1] row_mask:0xf bank_mask:0xf
  v_add_f32_dpp v51, v45, v51 quad_perm:[1,1,1,1] row_mask:0xf bank_mask:0xf
  v_add_f32_dpp v48, v34, v48 quad_perm:[2,2,2,2] row_mask:0xf bank_mask:0xf
  v_add_f32_dpp v49, v38, v49 quad_perm:[2,2,2,2] row_mask:0xf bank_mask:0xf
  v_add_f32_dpp v50, v42, v50 quad_perm:[2,2,2,2] row_mask:0xf bank_mask:0xf
  v_add_f32_dpp v51, v46, v51 quad_perm:[2,2,2,2] row_mask:0xf bank_mask:0xf
  v_add_f32_dpp v48, v35, v48 quad_perm:[3,3,3,3] row_mask:0xf bank_mask:0xf
  v_add_f32_dpp v49, v39, v49 quad_perm:[3,3,3,3] row_mask:0xf bank_mask:0xf
  v_add_f32_dpp v50, v43, v50 quad_perm:[3,3,3,3] row_mask:0xf bank_mask:0xf
  v_add_f32_dpp v51, v47, v51 quad_perm:[3,3,3,3] row_mask:0xf bank_mask:0xf
  v_cvt_pk_bf16_f32 v52, v48, v49
  v_cvt_pk_bf16_f32 v53, v50, v51
  v_lshlrev_b32 v48, 16, v52
  v_and_b32 v49, 0xffff0000, v52
  v_lshlrev_b32 v50, 16, v53
  v_and_b32 v51, 0xffff0000, v53
  v_max3_f32 v52, v48, v49, v50
  v_max_f32 v52, v52, v51
  v_cmp_gt_f32 vcc, v52, v28
  s_nop 0
  s_cbranch_vccnz L_rare_27
L_back_28:
  v_fma_f32 v52, v48, s60, -v29
  v_fma_f32 v53, v49, s60, -v29
  v_fma_f32 v54, v50, s60, -v29
  v_fma_f32 v55, v51, s60, -v29
  v_exp_f32 v52, v52
  v_exp_f32 v53, v53
  v_exp_f32 v54, v54
  v_exp_f32 v55, v55
  s_nop 0
  v_cvt_pk_bf16_f32 v56, v52, v52
  v_cvt_pk_bf16_f32 v57, v53, v53
  v_cvt_pk_bf16_f32 v58, v54, v54
  v_cvt_pk_bf16_f32 v59, v55, v55
  v_add_f32 v52, v52, v53
  v_add_f32 v54, v54, v55
  v_add_f32 v30, v30, v52
  v_add_f32 v30, v30, v54
  v_and_b32 v32, v8, v56
  v_and_b32 v33, v9, v56
  v_and_b32 v34, v10, v56
  v_and_b32 v35, v11, v56
  s_nop 1
  v_mfma_f32_16x16x32_bf16 v[20:23], v[32:35], v[160:163], v[20:23]
  v_mfma_f32_16x16x32_bf16 v[24:27], v[32:35], v[164:167], v[24:27]
  v_and_b32 v36, v8, v57
  v_and_b32 v37, v9, v57
  v_and_b32 v38, v10, v57
  v_and_b32 v39, v11, v57
  s_nop 1
  v_mfma_f32_16x16x32_bf16 v[20:23], v[36:39], v[168:171], v[20:23]
  v_mfma_f32_16x16x32_bf16 v[24:27], v[36:39], v[172:175], v[24:27]
  v_and_b32 v32, v8, v58
  v_and_b32 v33, v9, v58
  v_and_b32 v34, v10, v58
  v_and_b32 v35, v11, v58
  s_nop 1
  v_mfma_f32_16x16x32_bf16 v[20:23], v[32:35], v[176:179], v[20:23]
  v_mfma_f32_16x16x32_bf16 v[24:27], v[32:35], v[180:183], v[24:27]
  v_and_b32 v36, v8, v59
  v_and_b32 v37, v9, v59
  v_and_b32 v38, v10, v59
  v_and_b32 v39, v11, v59
  s_nop 1
  v_mfma_f32_16x16x32_bf16 v[20:23], v[36:39], v[184:187], v[20:23]
  v_mfma_f32_16x16x32_bf16 v[24:27], v[36:39], v[188:191], v[24:27]
  v_mfma_f32_16x16x32_bf16 v[32:35], v[192:195], v[12:15], 0
  v_mfma_f32_16x16x32_bf16 v[36:39], v[200:203], v[12:15], 0
  v_mfma_f32_16x16x32_bf16 v[40:43], v[208:211], v[12:15], 0
  v_mfma_f32_16x16x32_bf16 v[44:47], v[216:219], v[12:15], 0
  v_mfma_f32_16x16x32_bf16 v[32:35], v[196:199], v[16:19], v[32:35]
  v_mfma_f32_16x16x32_bf16 v[36:39], v[204:207], v[16:19], v[36:39]
  v_mfma_f32_16x16x32_bf16 v[40:43], v[212:215], v[16:19], v[40:43]
  v_mfma_f32_16x16x32_bf16 v[44:47], v[220:223], v[16:19], v[44:47]
  s_nop 7
  v_mov_b32_dpp v48, v32 quad_perm:[0,0,0,0] row_mask:0xf bank_mask:0xf
  v_mov_b32_dpp v49, v36 quad_perm:[0,0,0,0] row_mask:0xf bank_mask:0xf
  v_mov_b32_dpp v50, v40 quad_perm:[0,0,0,0] row_mask:0xf bank_mask:0xf
  v_mov_b32_dpp v51, v44 quad_perm:[0,0,0,0] row_mask:0xf bank_mask:0xf
  v_add_f32_dpp v48, v33, v48 quad_perm:[1,1,1,1] row_mask:0xf bank_mask:0xf
  v_add_f32_dpp v49, v37, v49 quad_perm:[1,1,1,1] row_mask:0xf bank_mask:0xf
  v_add_f32_dpp v50, v41, v50 quad_perm:[1,1,1,1] row_mask:0xf bank_mask:0xf
  v_add_f32_dpp v51, v45, v51 quad_perm:[1,1,1,1] row_mask:0xf bank_mask:0xf
  v_add_f32_dpp v48, v34, v48 quad_perm:[2,2,2,2] row_mask:0xf bank_mask:0xf
  v_add_f32_dpp v49, v38, v49 quad_perm:[2,2,2,2] row_mask:0xf bank_mask:0xf
  v_add_f32_dpp v50, v42, v50 quad_perm:[2,2,2,2] row_mask:0xf bank_mask:0xf
  v_add_f32_dpp v51, v46, v51 quad_perm:[2,2,2,2] row_mask:0xf bank_mask:0xf
  v_add_f32_dpp v48, v35, v48 quad_perm:[3,3,3,3] row_mask:0xf bank_mask:0xf
  v_add_f32_dpp v49, v39, v49 quad_perm:[3,3,3,3] row_mask:0xf bank_mask:0xf
  v_add_f32_dpp v50, v43, v50 quad_perm:[3,3,3,3] row_mask:0xf bank_mask:0xf
  v_add_f32_dpp v51, v47, v51 quad_perm:[3,3,3,3] row_mask:0xf bank_mask:0xf
  v_cvt_pk_bf16_f32 v52, v48, v49
  v_cvt_pk_bf16_f32 v53, v50, v51
  v_lshlrev_b32 v48, 16, v52
  v_and_b32 v49, 0xffff0000, v52
  v_lshlrev_b32 v50, 16, v53
  v_and_b32 v51, 0xffff0000, v53
  v_max3_f32 v52, v48, v49, v50
  v_max_f32 v52, v52, v51
  v_cmp_gt_f32 vcc, v52, v28
  s_nop 0
  s_cbranch_vccnz L_rare_29
L_back_30:
  v_fma_f32 v52, v48, s60, -v29
  v_fma_f32 v53, v49, s60, -v29
  v_fma_f32 v54, v50, s60, -v29
  v_fma_f32 v55, v51, s60, -v29
  v_exp_f32 v52, v52
  v_exp_f32 v53, v53
  v_exp_f32 v54, v54
  v_exp_f32 v55, v55
  s_nop 0
  v_cvt_pk_bf16_f32 v56, v52, v52
  v_cvt_pk_bf16_f32 v57, v53, v53
  v_cvt_pk_bf16_f32 v58, v54, v54
  v_cvt_pk_bf16_f32 v59, v55, v55
  v_add_f32 v52, v52, v53
  v_add_f32 v54, v54, v55
  v_add_f32 v30, v30, v52
  v_add_f32 v30, v30, v54
  s_waitcnt vmcnt(0)
  v_and_b32 v32, v8, v56
  v_and_b32 v33, v9, v56
  v_and_b32 v34, v10, v56
  v_and_b32 v35, v11, v56
  s_nop 1
  v_mfma_f32_16x16x32_bf16 v[20:23], v[32:35], v[224:227], v[20:23]
  v_mfma_f32_16x16x32_bf16 v[24:27], v[32:35], v[228:231], v[24:27]
  v_and_b32 v36, v8, v57
  v_and_b32 v37, v9, v57
  v_and_b32 v38, v10, v57
  v_and_b32 v39, v11, v57
  s_nop 1
  v_mfma_f32_16x16x32_bf16 v[20:23], v[36:39], v[232:235], v[20:23]
  v_mfma_f32_16x16x32_bf16 v[24:27], v[36:39], v[236:239], v[24:27]
  v_and_b32 v32, v8, v58
  v_and_b32 v33, v9, v58
  v_and_b32 v34, v10, v58
  v_and_b32 v35, v11, v58
  s_nop 1
  v_mfma_f32_16x16x32_bf16 v[20:23], v[32:35], v[240:243], v[20:23]
  v_mfma_f32_16x16x32_bf16 v[24:27], v[32:35], v[244:247], v[24:27]
  v_and_b32 v36, v8, v59
  v_and_b32 v37, v9, v59
  v_and_b32 v38, v10, v59
  v_and_b32 v39, v11, v59
  s_nop 1
  v_mfma_f32_16x16x32_bf16 v[20:23], v[36:39], v[248:251], v[20:23]
  v_mfma_f32_16x16x32_bf16 v[24:27], v[36:39], v[252:255], v[24:27]
  s_branch L_wfin
L_rare_7:
  v_mov_b32 v53, v52
  s_nop 1
  v_permlane16_swap_b32 v53, v52
  s_nop 0
  v_max_f32 v52, v53, v52
  v_mov_b32 v53, v52
  s_nop 1
  v_permlane32_swap_b32 v53, v52
  s_nop 0
  v_max_f32 v52, v53, v52
  v_max_f32 v52, v52, v28
  v_sub_f32 v53, v28, v52
  v_mul_f32 v53, s60, v53
  v_exp_f32 v53, v53
  v_mov_b32 v28, v52
  v_mul_f32 v29, s60, v52
  v_mul_f32 v30, v30, v53
  v_readlane_b32 s62, v53, 0
  v_readlane_b32 s63, v53, 8
  s_nop 1
  v_mov_b32 v54, s63
  v_mov_b32 v55, s62
  v_cndmask_b32 v54, v54, v55, s[64:65]
  s_nop 2
  v_mul_f32 v20, v20, v54
  v_mul_f32 v21, v21, v54
  v_mul_f32 v22, v22, v54
  v_mul_f32 v23, v23, v54
  v_mul_f32 v24, v24, v54
  v_mul_f32 v25, v25, v54
  v_mul_f32 v26, v26, v54
  v_mul_f32 v27, v27, v54
  s_nop 1
  s_branch L_back_8
L_rare_9:
  v_mov_b32 v53, v52
  s_nop 1
  v_permlane16_swap_b32 v53, v52
  s_nop 0
  v_max_f32 v52, v53, v52
  v_mov_b32 v53, v52
  s_nop 1
  v_permlane32_swap_b32 v53, v52
  s_nop 0
  v_max_f32 v52, v53, v52
  v_max_f32 v52, v52, v28
  v_sub_f32 v53, v28, v52
  v_mul_f32 v53, s60, v53
  v_exp_f32 v53, v53
  v_mov_b32 v28, v52
  v_mul_f32 v29, s60, v52
  v_mul_f32 v30, v30, v53
  v_readlane_b32 s62, v53, 0
  v_readlane_b32 s63, v53, 8
  s_nop 1
  v_mov_b32 v54, s63
  v_mov_b32 v55, s62
  v_cndmask_b32 v54, v54, v55, s[64:65]
  s_nop 2
  v_mul_f32 v20, v20, v54
  v_mul_f32 v21, v21, v54
  v_mul_f32 v22, v22, v54
  v_mul_f32 v23, v23, v54
  v_mul_f32 v24, v24, v54
  v_mul_f32 v25, v25, v54
  v_mul_f32 v26, v26, v54
  v_mul_f32 v27, v27, v54
  s_nop 1
  s_branch L_back_10
L_rare_11:
  v_mov_b32 v53, v52
  s_nop 1
  v_permlane16_swap_b32 v53, v52
  s_nop 0
  v_max_f32 v52, v53, v52
  v_mov_b32 v53, v52
  s_nop 1
  v_permlane32_swap_b32 v53, v52
  s_nop 0
  v_max_f32 v52, v53, v52
  v_max_f32 v52, v52, v28
  v_sub_f32 v53, v28, v52
  v_mul_f32 v53, s60, v53
  v_exp_f32 v53, v53
  v_mov_b32 v28, v52
  v_mul_f32 v29, s60, v52
  v_mul_f32 v30, v30, v53
  v_readlane_b32 s62, v53, 0
  v_readlane_b32 s63, v53, 8
  s_nop 1
  v_mov_b32 v54, s63
  v_mov_b32 v55, s62
  v_cndmask_b32 v54, v54, v55, s[64:65]
  s_nop 2
  v_mul_f32 v20, v20, v54
  v_mul_f32 v21, v21, v54
  v_mul_f32 v22, v22, v54
  v_mul_f32 v23, v23, v54
  v_mul_f32 v24, v24, v54
  v_mul_f32 v25, v25, v54
  v_mul_f32 v26, v26, v54
  v_mul_f32 v27, v27, v54
  s_nop 1
  s_branch L_back_12
L_rare_15:
  v_mov_b32 v53, v52
  s_nop 1
  v_permlane16_swap_b32 v53, v52
  s_nop 0
  v_max_f32 v52, v53, v52
  v_mov_b32 v53, v52
  s_nop 1
  v_permlane32_swap_b32 v53, v52
  s_nop 0
  v_max_f32 v52, v53, v52
  v_max_f32 v52, v52, v28
  v_sub_f32 v53, v28, v52
  v_mul_f32 v53, s60, v53
  v_exp_f32 v53, v53
  v_mov_b32 v28, v52
  v_mul_f32 v29, s60, v52
  v_mul_f32 v30, v30, v53
  v_readlane_b32 s62, v53, 0
  v_readlane_b32 s63, v53, 8
  s_nop 1
  v_mov_b32 v54, s63
  v_mov_b32 v55, s62
  v_cndmask_b32 v54, v54, v55, s[64:65]
  s_nop 2
  v_mul_f32 v20, v20, v54
  v_mul_f32 v21, v21, v54
  v_mul_f32 v22, v22, v54
  v_mul_f32 v23, v23, v54
  v_mul_f32 v24, v24, v54
  v_mul_f32 v25, v25, v54
  v_mul_f32 v26, v26, v54
  v_mul_f32 v27, v27, v54
  s_nop 1
  s_branch L_back_16
L_rare_17:
  v_mov_b32 v53, v52
  s_nop 1
  v_permlane16_swap_b32 v53, v52
  s_nop 0
  v_max_f32 v52, v53, v52
  v_mov_b32 v53, v52
  s_nop 1
  v_permlane32_swap_b32 v53, v52
  s_nop 0
  v_max_f32 v52, v53, v52
  v_max_f32 v52, v52, v28
  v_sub_f32 v53, v28, v52
  v_mul_f32 v53, s60, v53
  v_exp_f32 v53, v53
  v_mov_b32 v28, v52
  v_mul_f32 v29, s60, v52
  v_mul_f32 v30, v30, v53
  v_readlane_b32 s62, v53, 0
  v_readlane_b32 s63, v53, 8
  s_nop 1
  v_mov_b32 v54, s63
  v_mov_b32 v55, s62
  v_cndmask_b32 v54, v54, v55, s[64:65]
  s_nop 2
  v_mul_f32 v20, v20, v54
  v_mul_f32 v21, v21, v54
  v_mul_f32 v22, v22, v54
  v_mul_f32 v23, v23, v54
  v_mul_f32 v24, v24, v54
  v_mul_f32 v25, v25, v54
  v_mul_f32 v26, v26, v54
  v_mul_f32 v27, v27, v54
  s_nop 1
  s_branch L_back_18
L_rare_19:
  v_mov_b32 v53, v52
  s_nop 1
  v_permlane16_swap_b32 v53, v52
  s_nop 0
  v_max_f32 v52, v53, v52
  v_mov_b32 v53, v52
  s_nop 1
  v_permlane32_swap_b32 v53, v52
  s_nop 0
  v_max_f32 v52, v53, v52
  v_max_f32 v52, v52, v28
  v_sub_f32 v53, v28, v52
  v_mul_f32 v53, s60, v53
  v_exp_f32 v53, v53
  v_mov_b32 v28, v52
  v_mul_f32 v29, s60, v52
  v_mul_f32 v30, v30, v53
  v_readlane_b32 s62, v53, 0
  v_readlane_b32 s63, v53, 8
  s_nop 1
  v_mov_b32 v54, s63
  v_mov_b32 v55, s62
  v_cndmask_b32 v54, v54, v55, s[64:65]
  s_nop 2
  v_mul_f32 v20, v20, v54
  v_mul_f32 v21, v21, v54
  v_mul_f32 v22, v22, v54
  v_mul_f32 v23, v23, v54
  v_mul_f32 v24, v24, v54
  v_mul_f32 v25, v25, v54
  v_mul_f32 v26, v26, v54
  v_mul_f32 v27, v27, v54
  s_nop 1
  s_branch L_back_20
L_rare_21:
  v_mov_b32 v53, v52
  s_nop 1
  v_permlane16_swap_b32 v53, v52
  s_nop 0
  v_max_f32 v52, v53, v52
  v_mov_b32 v53, v52
  s_nop 1
  v_permlane32_swap_b32 v53, v52
  s_nop 0
  v_max_f32 v52, v53, v52
  v_max_f32 v52, v52, v28
  v_sub_f32 v53, v28, v52
  v_mul_f32 v53, s60, v53
  v_exp_f32 v53, v53
  v_mov_b32 v28, v52
  v_mul_f32 v29, s60, v52
  v_mul_f32 v30, v30, v53
  v_readlane_b32 s62, v53, 0
  v_readlane_b32 s63, v53, 8
  s_nop 1
  v_mov_b32 v54, s63
  v_mov_b32 v55, s62
  v_cndmask_b32 v54, v54, v55, s[64:65]
  s_nop 2
  v_mul_f32 v20, v20, v54
  v_mul_f32 v21, v21, v54
  v_mul_f32 v22, v22, v54
  v_mul_f32 v23, v23, v54
  v_mul_f32 v24, v24, v54
  v_mul_f32 v25, v25, v54
  v_mul_f32 v26, v26, v54
  v_mul_f32 v27, v27, v54
  s_nop 1
  s_branch L_back_22
L_rare_23:
  v_mov_b32 v53, v52
  s_nop 1
  v_permlane16_swap_b32 v53, v52
  s_nop 0
  v_max_f32 v52, v53, v52
  v_mov_b32 v53, v52
  s_nop 1
  v_permlane32_swap_b32 v53, v52
  s_nop 0
  v_max_f32 v52, v53, v52
  v_max_f32 v52, v52, v28
  v_sub_f32 v53, v28, v52
  v_mul_f32 v53, s60, v53
  v_exp_f32 v53, v53
  v_mov_b32 v28, v52
  v_mul_f32 v29, s60, v52
  v_mul_f32 v30, v30, v53
  v_readlane_b32 s62, v53, 0
  v_readlane_b32 s63, v53, 8
  s_nop 1
  v_mov_b32 v54, s63
  v_mov_b32 v55, s62
  v_cndmask_b32 v54, v54, v55, s[64:65]
  s_nop 2
  v_mul_f32 v20, v20, v54
  v_mul_f32 v21, v21, v54
  v_mul_f32 v22, v22, v54
  v_mul_f32 v23, v23, v54
  v_mul_f32 v24, v24, v54
  v_mul_f32 v25, v25, v54
  v_mul_f32 v26, v26, v54
  v_mul_f32 v27, v27, v54
  s_nop 1
  s_branch L_back_24
L_rare_25:
  v_mov_b32 v53, v52
  s_nop 1
  v_permlane16_swap_b32 v53, v52
  s_nop 0
  v_max_f32 v52, v53, v52
  v_mov_b32 v53, v52
  s_nop 1
  v_permlane32_swap_b32 v53, v52
  s_nop 0
  v_max_f32 v52, v53, v52
  v_max_f32 v52, v52, v28
  v_sub_f32 v53, v28, v52
  v_mul_f32 v53, s60, v53
  v_exp_f32 v53, v53
  v_mov_b32 v28, v52
  v_mul_f32 v29, s60, v52
  v_mul_f32 v30, v30, v53
  v_readlane_b32 s62, v53, 0
  v_readlane_b32 s63, v53, 8
  s_nop 1
  v_mov_b32 v54, s63
  v_mov_b32 v55, s62
  v_cndmask_b32 v54, v54, v55, s[64:65]
  s_nop 2
  v_mul_f32 v20, v20, v54
  v_mul_f32 v21, v21, v54
  v_mul_f32 v22, v22, v54
  v_mul_f32 v23, v23, v54
  v_mul_f32 v24, v24, v54
  v_mul_f32 v25, v25, v54
  v_mul_f32 v26, v26, v54
  v_mul_f32 v27, v27, v54
  s_nop 1
  s_branch L_back_26
L_rare_27:
  v_mov_b32 v53, v52
  s_nop 1
  v_permlane16_swap_b32 v53, v52
  s_nop 0
  v_max_f32 v52, v53, v52
  v_mov_b32 v53, v52
  s_nop 1
  v_permlane32_swap_b32 v53, v52
  s_nop 0
  v_max_f32 v52, v53, v52
  v_max_f32 v52, v52, v28
  v_sub_f32 v53, v28, v52
  v_mul_f32 v53, s60, v53
  v_exp_f32 v53, v53
  v_mov_b32 v28, v52
  v_mul_f32 v29, s60, v52
  v_mul_f32 v30, v30, v53
  v_readlane_b32 s62, v53, 0
  v_readlane_b32 s63, v53, 8
  s_nop 1
  v_mov_b32 v54, s63
  v_mov_b32 v55, s62
  v_cndmask_b32 v54, v54, v55, s[64:65]
  s_nop 2
  v_mul_f32 v20, v20, v54
  v_mul_f32 v21, v21, v54
  v_mul_f32 v22, v22, v54
  v_mul_f32 v23, v23, v54
  v_mul_f32 v24, v24, v54
  v_mul_f32 v25, v25, v54
  v_mul_f32 v26, v26, v54
  v_mul_f32 v27, v27, v54
  s_nop 1
  s_branch L_back_28
L_rare_29:
  v_mov_b32 v53, v52
  s_nop 1
  v_permlane16_swap_b32 v53, v52
  s_nop 0
  v_max_f32 v52, v53, v52
  v_mov_b32 v53, v52
  s_nop 1
  v_permlane32_swap_b32 v53, v52
  s_nop 0
  v_max_f32 v52, v53, v52
  v_max_f32 v52, v52, v28
  v_sub_f32 v53, v28, v52
  v_mul_f32 v53, s60, v53
  v_exp_f32 v53, v53
  v_mov_b32 v28, v52
  v_mul_f32 v29, s60, v52
  v_mul_f32 v30, v30, v53
  v_readlane_b32 s62, v53, 0
  v_readlane_b32 s63, v53, 8
  s_nop 1
  v_mov_b32 v54, s63
  v_mov_b32 v55, s62
  v_cndmask_b32 v54, v54, v55, s[64:65]
  s_nop 2
  v_mul_f32 v20, v20, v54
  v_mul_f32 v21, v21, v54
  v_mul_f32 v22, v22, v54
  v_mul_f32 v23, v23, v54
  v_mul_f32 v24, v24, v54
  v_mul_f32 v25, v25, v54
  v_mul_f32 v26, v26, v54
  v_mul_f32 v27, v27, v54
  s_nop 1
  s_branch L_back_30
L_wfin:
  v_mov_b32 v31, v30
  s_nop 1
  v_permlane16_swap_b32 v31, v30
  s_nop 0
  v_add_f32 v30, v31, v30
  v_mov_b32 v31, v30
  s_nop 1
  v_permlane32_swap_b32 v31, v30
  s_nop 0
  v_add_f32 v30, v31, v30
  v_lshrrev_b32 v62, 1, v3
  v_lshlrev_b32 v62, 10, v62
  v_lshl_add_u32 v62, v2, 5, v62
  v_and_b32 v1, 1, v3
  v_lshl_add_u32 v62, v1, 4, v62
  s_mul_i32 s31, s3, 2304
  s_add_u32 s31, s31, 25856
  v_add_u32 v62, s31, v62
  s_nop 3
  ds_write_b128 v62, v[20:23]
  ds_write_b128 v62, v[24:27] offset:512
  v_lshrrev_b32 v63, 3, v0
  v_lshlrev_b32 v63, 3, v63
  v_add_u32 v63, s31, v63
  v_mov_b32 v29, v30
  s_mov_b32 exec_lo, 0x101
  s_mov_b32 exec_hi, 0x0
  ds_write_b64 v63, v[28:29] offset:2048
  s_mov_b64 exec, -1
  s_waitcnt lgkmcnt(0)
  s_mul_i32 s31, s2, 8192
  s_add_u32 s31, s31, 65536
  v_mov_b32 v2, 27904
  v_lshlrev_b32 v3, 4, v0
  v_lshlrev_b32 v4, 3, v0
  v_mov_b32 v33, s34
  v_mov_b32 v35, s34
  s_lshl_b32 s30, s3, 9
  v_add_u32 v4, s30, v4
  s_lshl_b32 s30, s3, 10
  s_add_u32 s30, s30, s31
  s_lshr_b32 s66, s3, 1
  s_lshl_b32 s66, s66, 3
  v_add_u32 v5, s66, v2
  v_and_b32 v6, 1, v0
  v_lshlrev_b32 v6, 3, v6
  v_add_u32 v6, v6, v2
  s_barrier
  s_cmp_eq_u32 s3, 5
  s_cbranch_scc1 L_wffn
  s_cmp_gt_u32 s3, 4
  s_cbranch_scc1 L_end
  s_cmp_eq_u32 s3, 4
  s_cbranch_scc1 L_whead
  ds_read_b64 v[64:65], v5 offset:0
  ds_read_b64 v[66:67], v5 offset:2304
  ds_read_b64 v[68:69], v5 offset:4608
  ds_read_b64 v[70:71], v5 offset:6912
  ds_read_b64 v[72:73], v5 offset:9216
  ds_read_b64 v[74:75], v5 offset:11520
  ds_read_b64 v[76:77], v5 offset:13824
  ds_read_b64 v[80:81], v4 offset:25856
  ds_read_b64 v[82:83], v4 offset:28160
  ds_read_b64 v[84:85], v4 offset:30464
  ds_read_b64 v[86:87], v4 offset:32768
  ds_read_b64 v[88:89], v4 offset:35072
  ds_read_b64 v[90:91], v4 offset:37376
  ds_read_b64 v[92:93], v4 offset:39680
  s_waitcnt lgkmcnt(7)
  v_max_f32 v36, v64, v66
  v_max_f32 v36, v36, v68
  v_max_f32 v36, v36, v70
  v_max_f32 v36, v36, v72
  v_max_f32 v36, v36, v74
  v_max_f32 v36, v36, v76
  v_sub_f32 v64, v64, v36
  v_sub_f32 v66, v66, v36
  v_sub_f32 v68, v68, v36
  v_sub_f32 v70, v70, v36
  v_sub_f32 v72, v72, v36
  v_sub_f32 v74, v74, v36
  v_sub_f32 v76, v76, v36
  v_mul_f32 v64, s60, v64
  v_mul_f32 v66, s60, v66
  v_mul_f32 v68, s60, v68
  v_mul_f32 v70, s60, v70
  v_mul_f32 v72, s60, v72
  v_mul_f32 v74, s60, v74
  v_mul_f32 v76, s60, v76
  v_exp_f32 v64, v64
  v_exp_f32 v66, v66
  v_exp_f32 v68, v68
  v_exp_f32 v70, v70
  v_exp_f32 v72, v72
  v_exp_f32 v74, v74
  v_exp_f32 v76, v76
  s_waitcnt lgkmcnt(0)
  v_mul_f32 v32, v64, v80
  v_mul_f32 v34, v64, v81
  v_fmac_f32 v32, v66, v82
  v_fmac_f32 v34, v66, v83
  v_fmac_f32 v32, v68, v84
  v_fmac_f32 v34, v68, v85
  v_fmac_f32 v32, v70, v86
  v_fmac_f32 v34, v70, v87
  v_fmac_f32 v32, v72, v88
  v_fmac_f32 v34, v72, v89
  v_fmac_f32 v32, v74, v90
  v_fmac_f32 v34, v74, v91
  v_fmac_f32 v32, v76, v92
  v_fmac_f32 v34, v76, v93
  buffer_store_dwordx4 v[32:35], v3, s[16:19], s30 offen sc1
  s_cmp_ge_u32 s89, 112
  s_cbranch_scc1 L_end
  s_branch L_hop2
L_whead:
  ds_read_b64 v[64:65], v6 offset:0
  ds_read_b64 v[66:67], v6 offset:2304
  ds_read_b64 v[68:69], v6 offset:4608
  ds_read_b64 v[70:71], v6 offset:6912
  ds_read_b64 v[72:73], v6 offset:9216
  ds_read_b64 v[74:75], v6 offset:11520
  ds_read_b64 v[76:77], v6 offset:13824
  s_waitcnt lgkmcnt(0)
  v_max_f32 v32, v64, v66
  v_max_f32 v32, v32, v68
  v_max_f32 v32, v32, v70
  v_max_f32 v32, v32, v72
  v_max_f32 v32, v32, v74
  v_max_f32 v32, v32, v76
  v_sub_f32 v64, v64, v32
  v_sub_f32 v66, v66, v32
  v_sub_f32 v68, v68, v32
  v_sub_f32 v70, v70, v32
  v_sub_f32 v72, v72, v32
  v_sub_f32 v74, v74, v32
  v_sub_f32 v76, v76, v32
  v_mul_f32 v64, s60, v64
  v_mul_f32 v66, s60, v66
  v_mul_f32 v68, s60, v68
  v_mul_f32 v70, s60, v70
  v_mul_f32 v72, s60, v72
  v_mul_f32 v74, s60, v74
  v_mul_f32 v76, s60, v76
  v_exp_f32 v64, v64
  v_exp_f32 v66, v66
  v_exp_f32 v68, v68
  v_exp_f32 v70, v70
  v_exp_f32 v72, v72
  v_exp_f32 v74, v74
  v_exp_f32 v76, v76
  s_nop 0
  v_mul_f32 v34, v64, v65
  v_fmac_f32 v34, v66, v67
  v_fmac_f32 v34, v68, v69
  v_fmac_f32 v34, v70, v71
  v_fmac_f32 v34, v72, v73
  v_fmac_f32 v34, v74, v75
  v_fmac_f32 v34, v76, v77
  s_add_u32 s30, s31, 4096
  s_mov_b32 exec_lo, 0xff
  s_mov_b32 exec_hi, 0x0
  buffer_store_dwordx4 v[32:35], v3, s[16:19], s30 offen sc1
  s_branch L_end
L_wffn:
  s_cmp_ge_u32 s89, 112
  s_cbranch_scc1 L_end
  v_mul_u32_u24 v64, 3584, v0
  s_lshl_b32 s31, s89, 5
  s_add_u32 s31, s31, 3080192
  s_mov_b32 exec_lo, 0xfffffff
  s_mov_b32 exec_hi, 0x0
L_pollf_31:
  buffer_load_dwordx4 v[68:71], v64, s[16:19], s31 offen sc1
  buffer_load_dwordx4 v[72:75], v64, s[16:19], s31 offen offset:16 sc1
  s_waitcnt vmcnt(0)
  v_xor_b32 v65, s34, v69
  v_xor_b32 v66, s34, v71
  v_or_b32 v65, v65, v66
  v_xor_b32 v66, s34, v73
  v_or_b32 v65, v65, v66
  v_xor_b32 v66, s34, v75
  v_or_b32 v65, v65, v66
  v_cmp_ne_u32 vcc, 0, v65
  s_nop 0
  s_cbranch_vccz L_pollfd_32
  s_sleep 8
  s_branch L_pollf_31
L_pollfd_32:
  s_mov_b64 exec, -1
  v_cmp_gt_u32 vcc, 28, v0
  s_nop 1
  v_cndmask_b32 v68, 0, v68, vcc
  v_cndmask_b32 v70, 0, v70, vcc
  v_cndmask_b32 v72, 0, v72, vcc
  v_cndmask_b32 v74, 0, v74, vcc
  s_mov_b32 s20, s36
  s_and_b32 s21, s37, 0xffff
  s_mov_b32 s22, 896
  s_mov_b32 s23, 0x00020000
  s_lshl_b32 s31, s89, 3
  v_mov_b32 v64, 0
  buffer_load_dwordx2 v[80:81], v64, s[20:23], s31 offen nt
  s_nop 1
  v_add_f32_dpp v68, v68, v68 quad_perm:[1,0,3,2] row_mask:0xf bank_mask:0xf
  v_add_f32_dpp v70, v70, v70 quad_perm:[1,0,3,2] row_mask:0xf bank_mask:0xf
  v_add_f32_dpp v72, v72, v72 quad_perm:[1,0,3,2] row_mask:0xf bank_mask:0xf
  v_add_f32_dpp v74, v74, v74 quad_perm:[1,0,3,2] row_mask:0xf bank_mask:0xf
  v_add_f32_dpp v68, v68, v68 quad_perm:[2,3,0,1] row_mask:0xf bank_mask:0xf
  v_add_f32_dpp v70, v70, v70 quad_perm:[2,3,0,1] row_mask:0xf bank_mask:0xf
  v_add_f32_dpp v72, v72, v72 quad_perm:[2,3,0,1] row_mask:0xf bank_mask:0xf
  v_add_f32_dpp v74, v74, v74 quad_perm:[2,3,0,1] row_mask:0xf bank_mask:0xf
  v_add_f32_dpp v68, v68, v68 row_half_mirror row_mask:0xf bank_mask:0xf
  v_add_f32_dpp v70, v70, v70 row_half_mirror row_mask:0xf bank_mask:0xf
  v_add_f32_dpp v72, v72, v72 row_half_mirror row_mask:0xf bank_mask:0xf
  v_add_f32_dpp v74, v74, v74 row_half_mirror row_mask:0xf bank_mask:0xf
  v_add_f32_dpp v68, v68, v68 row_mirror row_mask:0xf bank_mask:0xf
  v_add_f32_dpp v70, v70, v70 row_mirror row_mask:0xf bank_mask:0xf
  v_add_f32_dpp v72, v72, v72 row_mirror row_mask:0xf bank_mask:0xf
  v_add_f32_dpp v74, v74, v74 row_mirror row_mask:0xf bank_mask:0xf
  v_mov_b32 v65, v68
  v_mov_b32 v66, v70
  v_mov_b32 v67, v72
  v_mov_b32 v76, v74
  s_nop 1
  v_permlane16_swap_b32 v65, v68
  v_permlane16_swap_b32 v66, v70
  v_permlane16_swap_b32 v67, v72
  v_permlane16_swap_b32 v76, v74
  s_nop 0
  v_add_f32 v68, v65, v68
  v_add_f32 v70, v66, v70
  v_add_f32 v72, v67, v72
  v_add_f32 v74, v76, v74
  v_mov_b32 v65, v68
  v_mov_b32 v66, v70
  v_mov_b32 v67, v72
  v_mov_b32 v76, v74
  s_nop 1
  v_permlane32_swap_b32 v65, v68
  v_permlane32_swap_b32 v66, v70
  v_permlane32_swap_b32 v67, v72
  v_permlane32_swap_b32 v76, v74
  s_nop 0
  v_add_f32 v68, v65, v68
  v_add_f32 v70, v66, v70
  v_add_f32 v72, v67, v72
  v_add_f32 v74, v76, v74
  v_cvt_pk_bf16_f32 v68, v68, v68
  v_and_b32 v68, 0xffff0000, v68
  v_cvt_pk_bf16_f32 v70, v70, v70
  v_and_b32 v70, 0xffff0000, v70
  v_cvt_pk_bf16_f32 v72, v72, v72
  v_and_b32 v72, 0xffff0000, v72
  v_cvt_pk_bf16_f32 v74, v74, v74
  v_and_b32 v74, 0xffff0000, v74
  v_mov_b32 v76, v68
  v_mov_b32 v77, v70
  v_mov_b32 v78, v72
  v_mov_b32 v79, v74
  v_mov_b32 v64, 42048
  s_waitcnt vmcnt(0)
  s_mov_b64 exec, 1
  ds_write_b128 v64, v[76:79]
  ds_write_b64 v64, v[80:81] offset:16
  s_mov_b64 exec, -1
  s_waitcnt lgkmcnt(0)
  s_barrier
  s_barrier
  s_branch L_end
L_hop2:
  s_barrier
  s_lshl_b32 s31, s3, 6
  v_add_u32 v1, s31, v0
  v_mul_u32_u24 v62, 3584, v1
  s_lshl_b32 s31, s89, 5
  s_add_u32 s31, s31, 2162688
L_poll2_33:
  buffer_load_dwordx4 v[32:35], v62, s[16:19], s31 offen sc1
  buffer_load_dwordx4 v[36:39], v62, s[16:19], s31 offen offset:16 sc1
  s_waitcnt vmcnt(0)
  v_xor_b32 v40, s34, v33
  v_xor_b32 v63, s34, v35
  v_or_b32 v40, v40, v63
  v_xor_b32 v63, s34, v37
  v_or_b32 v40, v40, v63
  v_xor_b32 v63, s34, v39
  v_or_b32 v40, v40, v63
  v_cmp_ne_u32 vcc, 0, v40
  s_nop 0
  s_cbranch_vccz L_poll2d_34
  s_mov_b64 exec, vcc
  s_sleep 1
  s_branch L_poll2_33
L_poll2d_34:
  s_mov_b64 exec, -1
  s_nop 1
  v_add_f32_dpp v32, v32, v32 quad_perm:[1,0,3,2] row_mask:0xf bank_mask:0xf
  v_add_f32_dpp v34, v34, v34 quad_perm:[1,0,3,2] row_mask:0xf bank_mask:0xf
  v_add_f32_dpp v36, v36, v36 quad_perm:[1,0,3,2] row_mask:0xf bank_mask:0xf
  v_add_f32_dpp v38, v38, v38 quad_perm:[1,0,3,2] row_mask:0xf bank_mask:0xf
  v_add_f32_dpp v32, v32, v32 quad_perm:[2,3,0,1] row_mask:0xf bank_mask:0xf
  v_add_f32_dpp v34, v34, v34 quad_perm:[2,3,0,1] row_mask:0xf bank_mask:0xf
  v_add_f32_dpp v36, v36, v36 quad_perm:[2,3,0,1] row_mask:0xf bank_mask:0xf
  v_add_f32_dpp v38, v38, v38 quad_perm:[2,3,0,1] row_mask:0xf bank_mask:0xf
  v_add_f32_dpp v32, v32, v32 row_half_mirror row_mask:0xf bank_mask:0xf
  v_add_f32_dpp v34, v34, v34 row_half_mirror row_mask:0xf bank_mask:0xf
  v_add_f32_dpp v36, v36, v36 row_half_mirror row_mask:0xf bank_mask:0xf
  v_add_f32_dpp v38, v38, v38 row_half_mirror row_mask:0xf bank_mask:0xf
  v_add_f32_dpp v32, v32, v32 row_mirror row_mask:0xf bank_mask:0xf
  v_add_f32_dpp v34, v34, v34 row_mirror row_mask:0xf bank_mask:0xf
  v_add_f32_dpp v36, v36, v36 row_mirror row_mask:0xf bank_mask:0xf
  v_add_f32_dpp v38, v38, v38 row_mirror row_mask:0xf bank_mask:0xf
  v_mov_b32 v40, v32
  v_mov_b32 v41, v34
  v_mov_b32 v42, v36
  v_mov_b32 v43, v38
  s_nop 1
  v_permlane16_swap_b32 v40, v32
  v_permlane16_swap_b32 v41, v34
  v_permlane16_swap_b32 v42, v36
  v_permlane16_swap_b32 v43, v38
  s_nop 0
  v_add_f32 v32, v40, v32
  v_add_f32 v34, v41, v34
  v_add_f32 v36, v42, v36
  v_add_f32 v38, v43, v38
  v_mov_b32 v40, v32
  v_mov_b32 v41, v34
  v_mov_b32 v42, v36
  v_mov_b32 v43, v38
  s_nop 1
  v_permlane32_swap_b32 v40, v32
  v_permlane32_swap_b32 v41, v34
  v_permlane32_swap_b32 v42, v36
  v_permlane32_swap_b32 v43, v38
  s_nop 0
  v_add_f32 v32, v40, v32
  v_add_f32 v34, v41, v34
  v_add_f32 v36, v42, v36
  v_add_f32 v38, v43, v38
  v_mov_b32 v33, v34
  v_mov_b32 v34, v36
  v_mov_b32 v35, v38
  s_lshl_b32 s31, s3, 4
  s_add_u32 s31, s31, 41984
  v_mov_b32 v62, s31
  s_mov_b64 exec, 1
  ds_write_b128 v62, v[32:35]
  s_mov_b64 exec, -1
  s_waitcnt lgkmcnt(0)
  s_barrier
  s_branch L_end
L_ffn:
  s_mov_b32 s20, s36
  s_and_b32 s21, s37, 0xffff
  s_mov_b32 s22, 896
  s_mov_b32 s23, 0x00020000
  v_lshlrev_b32 v1, 4, v0
  buffer_load_dwordx4 v[8:11], v1, s[20:23], 0 offen nt
  s_mov_b32 s20, s48
  s_and_b32 s21, s49, 0xffff
  s_mov_b32 s22, 1605632
  s_mov_b32 s23, 0x00020000
  s_mov_b32 s24, s50
  s_and_b32 s25, s51, 0xffff
  s_mov_b32 s26, 1605632
  s_mov_b32 s27, 0x00020000
  v_lshrrev_b32 v2, 3, v0
  s_mov_b32 s30, 3584
  v_mul_lo_u32 v2, v2, s30
  v_and_b32 v1, 7, v0
  v_lshl_add_u32 v2, v1, 4, v2
  s_lshl_b32 s30, s33, 7
  s_add_u32 s31, s30, 0
  buffer_load_dwordx4 v[64:67], v2, s[20:23], s31 offen nt
  s_add_u32 s31, s30, 28672
  buffer_load_dwordx4 v[68:71], v2, s[20:23], s31 offen nt
  s_add_u32 s31, s30, 57344
  buffer_load_dwordx4 v[72:75], v2, s[20:23], s31 offen nt
  s_add_u32 s31, s30, 86016
  buffer_load_dwordx4 v[76:79], v2, s[20:23], s31 offen nt
  s_add_u32 s31, s30, 114688
  buffer_load_dwordx4 v[80:83], v2, s[20:23], s31 offen nt
  s_add_u32 s31, s30, 143360
  buffer_load_dwordx4 v[84:87], v2, s[20:23], s31 offen nt
  s_add_u32 s31, s30, 172032
  buffer_load_dwordx4 v[88:91], v2, s[20:23], s31 offen nt
  s_add_u32 s31, s30, 200704
  buffer_load_dwordx4 v[92:95], v2, s[20:23], s31 offen nt
  s_add_u32 s31, s30, 229376
  buffer_load_dwordx4 v[96:99], v2, s[20:23], s31 offen nt
  s_add_u32 s31, s30, 258048
  buffer_load_dwordx4 v[100:103], v2, s[20:23], s31 offen nt
  s_add_u32 s31, s30, 286720
  buffer_load_dwordx4 v[104:107], v2, s[20:23], s31 offen nt
  s_add_u32 s31, s30, 315392
  buffer_load_dwordx4 v[108:111], v2, s[20:23], s31 offen nt
  s_add_u32 s31, s30, 344064
  buffer_load_dwordx4 v[112:115], v2, s[20:23], s31 offen nt
  s_add_u32 s31, s30, 372736
  buffer_load_dwordx4 v[116:119], v2, s[20:23], s31 offen nt
  s_add_u32 s31, s30, 401408
  buffer_load_dwordx4 v[120:123], v2, s[20:23], s31 offen nt
  s_add_u32 s31, s30, 430080
  buffer_load_dwordx4 v[124:127], v2, s[20:23], s31 offen nt
  s_add_u32 s31, s30, 458752
  buffer_load_dwordx4 v[128:131], v2, s[20:23], s31 offen nt
  s_add_u32 s31, s30, 487424
  buffer_load_dwordx4 v[132:135], v2, s[20:23], s31 offen nt
  s_add_u32 s31, s30, 516096
  buffer_load_dwordx4 v[136:139], v2, s[20:23], s31 offen nt
  s_add_u32 s31, s30, 544768
  buffer_load_dwordx4 v[140:143], v2, s[20:23], s31 offen nt
  s_add_u32 s31, s30, 573440
  buffer_load_dwordx4 v[144:147], v2, s[20:23], s31 offen nt
  s_add_u32 s31, s30, 602112
  buffer_load_dwordx4 v[148:151], v2, s[20:23], s31 offen nt
  s_add_u32 s31, s30, 630784
  buffer_load_dwordx4 v[152:155], v2, s[20:23], s31 offen nt
  s_add_u32 s31, s30, 659456
  buffer_load_dwordx4 v[156:159], v2, s[20:23], s31 offen nt
  s_add_u32 s31, s30, 688128
  buffer_load_dwordx4 v[160:163], v2, s[20:23], s31 offen nt
  s_add_u32 s31, s30, 716800
  buffer_load_dwordx4 v[164:167], v2, s[20:23], s31 offen nt
  s_add_u32 s31, s30, 745472
  buffer_load_dwordx4 v[168:171], v2, s[20:23], s31 offen nt
  s_add_u32 s31, s30, 774144
  buffer_load_dwordx4 v[172:175], v2, s[20:23], s31 offen nt
  s_add_u32 s31, s30, 802816
  buffer_load_dwordx4 v[176:179], v2, s[20:23], s31 offen nt
  s_add_u32 s31, s30, 831488
  buffer_load_dwordx4 v[180:183], v2, s[20:23], s31 offen nt
  s_add_u32 s31, s30, 860160
  buffer_load_dwordx4 v[184:187], v2, s[20:23], s31 offen nt
  s_add_u32 s31, s30, 888832
  buffer_load_dwordx4 v[188:191], v2, s[20:23], s31 offen nt
  s_add_u32 s31, s30, 917504
  buffer_load_dwordx4 v[192:195], v2, s[20:23], s31 offen nt
  s_add_u32 s31, s30, 946176
  buffer_load_dwordx4 v[196:199], v2, s[20:23], s31 offen nt
  s_add_u32 s31, s30, 974848
  buffer_load_dwordx4 v[200:203], v2, s[20:23], s31 offen nt
  s_add_u32 s31, s30, 1003520
  buffer_load_dwordx4 v[204:207], v2, s[20:23], s31 offen nt
  s_add_u32 s31, s30, 1032192
  buffer_load_dwordx4 v[208:211], v2, s[20:23], s31 offen nt
  s_add_u32 s31, s30, 1060864
  buffer_load_dwordx4 v[212:215], v2, s[20:23], s31 offen nt
  s_add_u32 s31, s30, 1089536
  buffer_load_dwordx4 v[216:219], v2, s[20:23], s31 offen nt
  s_add_u32 s31, s30, 1118208
  buffer_load_dwordx4 v[220:223], v2, s[20:23], s31 offen nt
  s_add_u32 s31, s30, 1146880
  buffer_load_dwordx4 v[224:227], v2, s[20:23], s31 offen nt
  s_add_u32 s31, s30, 1175552
  buffer_load_dwordx4 v[228:231], v2, s[20:23], s31 offen nt
  s_barrier
  s_waitcnt lgkmcnt(0)
  s_add_u32 s34, s35, 1
  s_waitcnt vmcnt(42)
  v_lshlrev_b32 v12, 16, v8
  v_and_b32 v13, 0xffff0000, v8
  v_lshlrev_b32 v14, 16, v9
  v_and_b32 v15, 0xffff0000, v9
  v_lshlrev_b32 v16, 16, v10
  v_and_b32 v17, 0xffff0000, v10
  v_lshlrev_b32 v18, 16, v11
  v_and_b32 v19, 0xffff0000, v11
  v_add_f32 v20, v12, v13
  v_add_f32 v20, v20, v14
  v_add_f32 v20, v20, v15
  v_add_f32 v20, v20, v16
  v_add_f32 v20, v20, v17
  v_add_f32 v20, v20, v18
  v_add_f32 v20, v20, v19
  s_nop 1
  v_add_f32_dpp v20, v20, v20 quad_perm:[1,0,3,2] row_mask:0xf bank_mask:0xf
  s_nop 1
  v_add_f32_dpp v20, v20, v20 quad_perm:[2,3,0,1] row_mask:0xf bank_mask:0xf
  s_nop 1
  v_add_f32_dpp v20, v20, v20 row_half_mirror row_mask:0xf bank_mask:0xf
  s_nop 1
  v_add_f32_dpp v20, v20, v20 row_mirror row_mask:0xf bank_mask:0xf
  v_mov_b32 v21, v20
  s_nop 1
  v_permlane16_swap_b32 v21, v20
  s_nop 0
  v_add_f32 v20, v21, v20
  v_mov_b32 v21, v20
  s_nop 1
  v_permlane32_swap_b32 v21, v20
  s_nop 0
  v_add_f32 v20, v21, v20
  v_mul_f32 v20, 0x3b124925, v20
  v_cmp_gt_u32 vcc, 56, v0
  v_mov_b32 v22, 0
  v_sub_f32 v23, v12, v20
  v_fmac_f32 v22, v23, v23
  v_sub_f32 v23, v13, v20
  v_fmac_f32 v22, v23, v23
  v_sub_f32 v23, v14, v20
  v_fmac_f32 v22, v23, v23
  v_sub_f32 v23, v15, v20
  v_fmac_f32 v22, v23, v23
  v_sub_f32 v23, v16, v20
  v_fmac_f32 v22, v23, v23
  v_sub_f32 v23, v17, v20
  v_fmac_f32 v22, v23, v23
  v_sub_f32 v23, v18, v20
  v_fmac_f32 v22, v23, v23
  v_sub_f32 v23, v19, v20
  v_fmac_f32 v22, v23, v23
  v_cndmask_b32 v22, 0, v22, vcc
  s_nop 1
  v_add_f32_dpp v22, v22, v22 quad_perm:[1,0,3,2] row_mask:0xf bank_mask:0xf
  s_nop 1
  v_add_f32_dpp v22, v22, v22 quad_perm:[2,3,0,1] row_mask:0xf bank_mask:0xf
  s_nop 1
  v_add_f32_dpp v22, v22, v22 row_half_mirror row_mask:0xf bank_mask:0xf
  s_nop 1
  v_add_f32_dpp v22, v22, v22 row_mirror row_mask:0xf bank_mask:0xf
  v_mov_b32 v21, v22
  s_nop 1
  v_permlane16_swap_b32 v21, v22
  s_nop 0
  v_add_f32 v22, v21, v22
  v_mov_b32 v21, v22
  s_nop 1
  v_permlane32_swap_b32 v21, v22
  s_nop 0
  v_add_f32 v22, v21, v22
  v_mul_f32 v22, 0x3b124925, v22
  v_cvt_pk_bf16_f32 v22, v22, v22
  v_and_b32 v22, 0xffff0000, v22
  v_cvt_pk_bf16_f32 v20, v20, v20
  v_and_b32 v20, 0xffff0000, v20
  v_add_f32 v22, 0x3727c5ac, v22
  v_cvt_pk_bf16_f32 v22, v22, v22
  v_and_b32 v22, 0xffff0000, v22
  v_sqrt_f32 v22, v22
  s_nop 0
  v_cvt_pk_bf16_f32 v22, v22, v22
  v_and_b32 v22, 0xffff0000, v22
  v_rcp_f32 v23, v22
  s_nop 0
  v_sub_f32 v12, v12, v20
  v_cvt_pk_bf16_f32 v12, v12, v12
  v_and_b32 v12, 0xffff0000, v12
  v_mul_f32 v24, v12, v23
  v_fma_f32 v25, -v24, v22, v12
  v_fma_f32 v24, v25, v23, v24
  v_cvt_pk_bf16_f32 v12, v24, v24
  v_sub_f32 v13, v13, v20
  v_cvt_pk_bf16_f32 v13, v13, v13
  v_and_b32 v13, 0xffff0000, v13
  v_mul_f32 v24, v13, v23
  v_fma_f32 v25, -v24, v22, v13
  v_fma_f32 v24, v25, v23, v24
  v_cvt_pk_bf16_f32 v13, v24, v24
  v_sub_f32 v14, v14, v20
  v_cvt_pk_bf16_f32 v14, v14, v14
  v_and_b32 v14, 0xffff0000, v14
  v_mul_f32 v24, v14, v23
  v_fma_f32 v25, -v24, v22, v14
  v_fma_f32 v24, v25, v23, v24
  v_cvt_pk_bf16_f32 v14, v24, v24
  v_sub_f32 v15, v15, v20
  v_cvt_pk_bf16_f32 v15, v15, v15
  v_and_b32 v15, 0xffff0000, v15
  v_mul_f32 v24, v15, v23
  v_fma_f32 v25, -v24, v22, v15
  v_fma_f32 v24, v25, v23, v24
  v_cvt_pk_bf16_f32 v15, v24, v24
  v_sub_f32 v16, v16, v20
  v_cvt_pk_bf16_f32 v16, v16, v16
  v_and_b32 v16, 0xffff0000, v16
  v_mul_f32 v24, v16, v23
  v_fma_f32 v25, -v24, v22, v16
  v_fma_f32 v24, v25, v23, v24
  v_cvt_pk_bf16_f32 v16, v24, v24
  v_sub_f32 v17, v17, v20
  v_cvt_pk_bf16_f32 v17, v17, v17
  v_and_b32 v17, 0xffff0000, v17
  v_mul_f32 v24, v17, v23
  v_fma_f32 v25, -v24, v22, v17
  v_fma_f32 v24, v25, v23, v24
  v_cvt_pk_bf16_f32 v17, v24, v24
  v_sub_f32 v18, v18, v20
  v_cvt_pk_bf16_f32 v18, v18, v18
  v_and_b32 v18, 0xffff0000, v18
  v_mul_f32 v24, v18, v23
  v_fma_f32 v25, -v24, v22, v18
  v_fma_f32 v24, v25, v23, v24
  v_cvt_pk_bf16_f32 v18, v24, v24
  v_sub_f32 v19, v19, v20
  v_cvt_pk_bf16_f32 v19, v19, v19
  v_and_b32 v19, 0xffff0000, v19
  v_mul_f32 v24, v19, v23
  v_fma_f32 v25, -v24, v22, v19
  v_fma_f32 v24, v25, v23, v24
  v_cvt_pk_bf16_f32 v19, v24, v24
  v_lshlrev_b32 v26, 5, v0
  s_mov_b32 exec_lo, 0xffffffff
  s_mov_b32 exec_hi, 0xffffff
  ds_write_b128 v26, v[12:15] offset:14592
  ds_write_b128 v26, v[16:19] offset:14608
  s_mov_b64 exec, -1
  s_waitcnt lgkmcnt(0)
  v_and_b32 v1, 1, v0
  v_lshlrev_b32 v1, 4, v1
  v_mov_b32 v31, 0xffff
  v_lshlrev_b32 v31, v1, v31
  v_bfe_u32 v1, v0, 1, 2
  v_cmp_eq_u32 vcc, 0, v1
  s_nop 1
  v_cndmask_b32 v8, 0, v31, vcc
  v_cmp_eq_u32 vcc, 1, v1
  s_nop 1
  v_cndmask_b32 v9, 0, v31, vcc
  v_cmp_eq_u32 vcc, 2, v1
  s_nop 1
  v_cndmask_b32 v10, 0, v31, vcc
  v_cmp_eq_u32 vcc, 3, v1
  s_nop 1
  v_cndmask_b32 v11, 0, v31, vcc
  v_lshrrev_b32 v3, 3, v0
  v_lshlrev_b32 v3, 2, v3
  ds_read_b32 v32, v3 offset:14592
  ds_read_b32 v33, v3 offset:14624
  ds_read_b32 v34, v3 offset:14656
  ds_read_b32 v35, v3 offset:14688
  ds_read_b32 v36, v3 offset:14720
  ds_read_b32 v37, v3 offset:14752
  ds_read_b32 v38, v3 offset:14784
  ds_read_b32 v39, v3 offset:14816
  ds_read_b32 v40, v3 offset:14848
  ds_read_b32 v41, v3 offset:14880
  ds_read_b32 v42, v3 offset:14912
  ds_read_b32 v43, v3 offset:14944
  ds_read_b32 v44, v3 offset:14976
  ds_read_b32 v45, v3 offset:15008
  s_waitcnt vmcnt(28) lgkmcnt(0)
  v_and_b32 v48, v8, v32
  v_and_b32 v49, v9, v32
  v_and_b32 v50, v10, v32
  v_and_b32 v51, v11, v32
  s_nop 1
  v_mfma_f32_16x16x32_bf16 v[56:59], v[48:51], v[64:67], 0
  v_and_b32 v52, v8, v33
  v_and_b32 v53, v9, v33
  v_and_b32 v54, v10, v33
  v_and_b32 v55, v11, v33
  s_nop 1
  v_mfma_f32_16x16x32_bf16 v[56:59], v[52:55], v[68:71], v[56:59]
  v_and_b32 v48, v8, v34
  v_and_b32 v49, v9, v34
  v_and_b32 v50, v10, v34
  v_and_b32 v51, v11, v34
  s_nop 1
  v_mfma_f32_16x16x32_bf16 v[56:59], v[48:51], v[72:75], v[56:59]
  v_and_b32 v52, v8, v35
  v_and_b32 v53, v9, v35
  v_and_b32 v54, v10, v35
  v_and_b32 v55, v11, v35
  s_nop 1
  v_mfma_f32_16x16x32_bf16 v[56:59], v[52:55], v[76:79], v[56:59]
  v_and_b32 v48, v8, v36
  v_and_b32 v49, v9, v36
  v_and_b32 v50, v10, v36
  v_and_b32 v51, v11, v36
  s_nop 1
  v_mfma_f32_16x16x32_bf16 v[56:59], v[48:51], v[80:83], v[56:59]
  v_and_b32 v52, v8, v37
  v_and_b32 v53, v9, v37
  v_and_b32 v54, v10, v37
  v_and_b32 v55, v11, v37
  s_nop 1
  v_mfma_f32_16x16x32_bf16 v[56:59], v[52:55], v[84:87], v[56:59]
  v_and_b32 v48, v8, v38
  v_and_b32 v49, v9, v38
  v_and_b32 v50, v10, v38
  v_and_b32 v51, v11, v38
  s_nop 1
  v_mfma_f32_16x16x32_bf16 v[56:59], v[48:51], v[88:91], v[56:59]
  v_and_b32 v52, v8, v39
  v_and_b32 v53, v9, v39
  v_and_b32 v54, v10, v39
  v_and_b32 v55, v11, v39
  s_nop 1
  v_mfma_f32_16x16x32_bf16 v[56:59], v[52:55], v[92:95], v[56:59]
  v_and_b32 v48, v8, v40
  v_and_b32 v49, v9, v40
  v_and_b32 v50, v10, v40
  v_and_b32 v51, v11, v40
  s_nop 1
  v_mfma_f32_16x16x32_bf16 v[56:59], v[48:51], v[96:99], v[56:59]
  v_and_b32 v52, v8, v41
  v_and_b32 v53, v9, v41
  v_and_b32 v54, v10, v41
  v_and_b32 v55, v11, v41
  s_nop 1
  v_mfma_f32_16x16x32_bf16 v[56:59], v[52:55], v[100:103], v[56:59]
  v_and_b32 v48, v8, v42
  v_and_b32 v49, v9, v42
  v_and_b32 v50, v10, v42
  v_and_b32 v51, v11, v42
  s_nop 1
  v_mfma_f32_16x16x32_bf16 v[56:59], v[48:51], v[104:107], v[56:59]
  v_and_b32 v52, v8, v43
  v_and_b32 v53, v9, v43
  v_and_b32 v54, v10, v43
  v_and_b32 v55, v11, v43
  s_nop 1
  v_mfma_f32_16x16x32_bf16 v[56:59], v[52:55], v[108:111], v[56:59]
  v_and_b32 v48, v8, v44
  v_and_b32 v49, v9, v44
  v_and_b32 v50, v10, v44
  v_and_b32 v51, v11, v44
  s_nop 1
  v_mfma_f32_16x16x32_bf16 v[56:59], v[48:51], v[112:115], v[56:59]
  v_and_b32 v52, v8, v45
  v_and_b32 v53, v9, v45
  v_and_b32 v54, v10, v45
  v_and_b32 v55, v11, v45
  s_nop 1
  v_mfma_f32_16x16x32_bf16 v[56:59], v[52:55], v[116:119], v[56:59]
  s_add_u32 s31, s30, 1204224
  buffer_load_dwordx4 v[64:67], v2, s[20:23], s31 offen nt
  s_add_u32 s31, s30, 1232896
  buffer_load_dwordx4 v[68:71], v2, s[20:23], s31 offen nt
  s_add_u32 s31, s30, 1261568
  buffer_load_dwordx4 v[72:75], v2, s[20:23], s31 offen nt
  s_add_u32 s31, s30, 1290240
  buffer_load_dwordx4 v[76:79], v2, s[20:23], s31 offen nt
  s_add_u32 s31, s30, 1318912
  buffer_load_dwordx4 v[80:83], v2, s[20:23], s31 offen nt
  s_add_u32 s31, s30, 1347584
  buffer_load_dwordx4 v[84:87], v2, s[20:23], s31 offen nt
  s_add_u32 s31, s30, 1376256
  buffer_load_dwordx4 v[88:91], v2, s[20:23], s31 offen nt
  s_add_u32 s31, s30, 1404928
  buffer_load_dwordx4 v[92:95], v2, s[20:23], s31 offen nt
  s_add_u32 s31, s30, 1433600
  buffer_load_dwordx4 v[96:99], v2, s[20:23], s31 offen nt
  s_add_u32 s31, s30, 1462272
  buffer_load_dwordx4 v[100:103], v2, s[20:23], s31 offen nt
  s_add_u32 s31, s30, 1490944
  buffer_load_dwordx4 v[104:107], v2, s[20:23], s31 offen nt
  s_add_u32 s31, s30, 1519616
  buffer_load_dwordx4 v[108:111], v2, s[20:23], s31 offen nt
  s_add_u32 s31, s30, 1548288
  buffer_load_dwordx4 v[112:115], v2, s[20:23], s31 offen nt
  s_add_u32 s31, s30, 1576960
  buffer_load_dwordx4 v[116:119], v2, s[20:23], s31 offen nt
  ds_read_b32 v32, v3 offset:15040
  ds_read_b32 v33, v3 offset:15072
  ds_read_b32 v34, v3 offset:15104
  ds_read_b32 v35, v3 offset:15136
  ds_read_b32 v36, v3 offset:15168
  ds_read_b32 v37, v3 offset:15200
  ds_read_b32 v38, v3 offset:15232
  ds_read_b32 v39, v3 offset:15264
  ds_read_b32 v40, v3 offset:15296
  ds_read_b32 v41, v3 offset:15328
  ds_read_b32 v42, v3 offset:15360
  ds_read_b32 v43, v3 offset:15392
  ds_read_b32 v44, v3 offset:15424
  ds_read_b32 v45, v3 offset:15456
  s_waitcnt vmcnt(28) lgkmcnt(0)
  v_and_b32 v48, v8, v32
  v_and_b32 v49, v9, v32
  v_and_b32 v50, v10, v32
  v_and_b32 v51, v11, v32
  s_nop 1
  v_mfma_f32_16x16x32_bf16 v[56:59], v[48:51], v[120:123], v[56:59]
  v_and_b32 v52, v8, v33
  v_and_b32 v53, v9, v33
  v_and_b32 v54, v10, v33
  v_and_b32 v55, v11, v33
  s_nop 1
  v_mfma_f32_16x16x32_bf16 v[56:59], v[52:55], v[124:127], v[56:59]
  v_and_b32 v48, v8, v34
  v_and_b32 v49, v9, v34
  v_and_b32 v50, v10, v34
  v_and_b32 v51, v11, v34
  s_nop 1
  v_mfma_f32_16x16x32_bf16 v[56:59], v[48:51], v[128:131], v[56:59]
  v_and_b32 v52, v8, v35
  v_and_b32 v53, v9, v35
  v_and_b32 v54, v10, v35
  v_and_b32 v55, v11, v35
  s_nop 1
  v_mfma_f32_16x16x32_bf16 v[56:59], v[52:55], v[132:135], v[56:59]
  v_and_b32 v48, v8, v36
  v_and_b32 v49, v9, v36
  v_and_b32 v50, v10, v36
  v_and_b32 v51, v11, v36
  s_nop 1
  v_mfma_f32_16x16x32_bf16 v[56:59], v[48:51], v[136:139], v[56:59]
  v_and_b32 v52, v8, v37
  v_and_b32 v53, v9, v37
  v_and_b32 v54, v10, v37
  v_and_b32 v55, v11, v37
  s_nop 1
  v_mfma_f32_16x16x32_bf16 v[56:59], v[52:55], v[140:143], v[56:59]
  v_and_b32 v48, v8, v38
  v_and_b32 v49, v9, v38
  v_and_b32 v50, v10, v38
  v_and_b32 v51, v11, v38
  s_nop 1
  v_mfma_f32_16x16x32_bf16 v[56:59], v[48:51], v[144:147], v[56:59]
  v_and_b32 v52, v8, v39
  v_and_b32 v53, v9, v39
  v_and_b32 v54, v10, v39
  v_and_b32 v55, v11, v39
  s_nop 1
  v_mfma_f32_16x16x32_bf16 v[56:59], v[52:55], v[148:151], v[56:59]
  v_and_b32 v48, v8, v40
  v_and_b32 v49, v9, v40
  v_and_b32 v50, v10, v40
  v_and_b32 v51, v11, v40
  s_nop 1
  v_mfma_f32_16x16x32_bf16 v[56:59], v[48:51], v[152:155], v[56:59]
  v_and_b32 v52, v8, v41
  v_and_b32 v53, v9, v41
  v_and_b32 v54, v10, v41
  v_and_b32 v55, v11, v41
  s_nop 1
  v_mfma_f32_16x16x32_bf16 v[56:59], v[52:55], v[156:159], v[56:59]
  v_and_b32 v48, v8, v42
  v_and_b32 v49, v9, v42
  v_and_b32 v50, v10, v42
  v_and_b32 v51, v11, v42
  s_nop 1
  v_mfma_f32_16x16x32_bf16 v[56:59], v[48:51], v[160:163], v[56:59]
  v_and_b32 v52, v8, v43
  v_and_b32 v53, v9, v43
  v_and_b32 v54, v10, v43
  v_and_b32 v55, v11, v43
  s_nop 1
  v_mfma_f32_16x16x32_bf16 v[56:59], v[52:55], v[164:167], v[56:59]
  v_and_b32 v48, v8, v44
  v_and_b32 v49, v9, v44
  v_and_b32 v50, v10, v44
  v_and_b32 v51, v11, v44
  s_nop 1
  v_mfma_f32_16x16x32_bf16 v[56:59], v[48:51], v[168:171], v[56:59]
  v_and_b32 v52, v8, v45
  v_and_b32 v53, v9, v45
  v_and_b32 v54, v10, v45
  v_and_b32 v55, v11, v45
  s_nop 1
  v_mfma_f32_16x16x32_bf16 v[56:59], v[52:55], v[172:175], v[56:59]
  s_add_u32 s31, s30, 0
  buffer_load_dwordx4 v[120:123], v2, s[24:27], s31 offen nt
  s_add_u32 s31, s30, 28672
  buffer_load_dwordx4 v[124:127], v2, s[24:27], s31 offen nt
  s_add_u32 s31, s30, 57344
  buffer_load_dwordx4 v[128:131], v2, s[24:27], s31 offen nt
  s_add_u32 s31, s30, 86016
  buffer_load_dwordx4 v[132:135], v2, s[24:27], s31 offen nt
  s_add_u32 s31, s30, 114688
  buffer_load_dwordx4 v[136:139], v2, s[24:27], s31 offen nt
  s_add_u32 s31, s30, 143360
  buffer_load_dwordx4 v[140:143], v2, s[24:27], s31 offen nt
  s_add_u32 s31, s30, 172032
  buffer_load_dwordx4 v[144:147], v2, s[24:27], s31 offen nt
  s_add_u32 s31, s30, 200704
  buffer_load_dwordx4 v[148:151], v2, s[24:27], s31 offen nt
  s_add_u32 s31, s30, 229376
  buffer_load_dwordx4 v[152:155], v2, s[24:27], s31 offen nt
  s_add_u32 s31, s30, 258048
  buffer_load_dwordx4 v[156:159], v2, s[24:27], s31 offen nt
  s_add_u32 s31, s30, 286720
  buffer_load_dwordx4 v[160:163], v2, s[24:27], s31 offen nt
  s_add_u32 s31, s30, 315392
  buffer_load_dwordx4 v[164:167], v2, s[24:27], s31 offen nt
  s_add_u32 s31, s30, 344064
  buffer_load_dwordx4 v[168:171], v2, s[24:27], s31 offen nt
  s_add_u32 s31, s30, 372736
  buffer_load_dwordx4 v[172:175], v2, s[24:27], s31 offen nt
  ds_read_b32 v32, v3 offset:15488
  ds_read_b32 v33, v3 offset:15520
  ds_read_b32 v34, v3 offset:15552
  ds_read_b32 v35, v3 offset:15584
  ds_read_b32 v36, v3 offset:15616
  ds_read_b32 v37, v3 offset:15648
  ds_read_b32 v38, v3 offset:15680
  ds_read_b32 v39, v3 offset:15712
  ds_read_b32 v40, v3 offset:15744
  ds_read_b32 v41, v3 offset:15776
  ds_read_b32 v42, v3 offset:15808
  ds_read_b32 v43, v3 offset:15840
  ds_read_b32 v44, v3 offset:15872
  ds_read_b32 v45, v3 offset:15904
  s_waitcnt vmcnt(28) lgkmcnt(0)
  v_and_b32 v48, v8, v32
  v_and_b32 v49, v9, v32
  v_and_b32 v50, v10, v32
  v_and_b32 v51, v11, v32
  s_nop 1
  v_mfma_f32_16x16x32_bf16 v[56:59], v[48:51], v[176:179], v[56:59]
  v_and_b32 v52, v8, v33
  v_and_b32 v53, v9, v33
  v_and_b32 v54, v10, v33
  v_and_b32 v55, v11, v33
  s_nop 1
  v_mfma_f32_16x16x32_bf16 v[56:59], v[52:55], v[180:183], v[56:59]
  v_and_b32 v48, v8, v34
  v_and_b32 v49, v9, v34
  v_and_b32 v50, v10, v34
  v_and_b32 v51, v11, v34
  s_nop 1
  v_mfma_f32_16x16x32_bf16 v[56:59], v[48:51], v[184:187], v[56:59]
  v_and_b32 v52, v8, v35
  v_and_b32 v53, v9, v35
  v_and_b32 v54, v10, v35
  v_and_b32 v55, v11, v35
  s_nop 1
  v_mfma_f32_16x16x32_bf16 v[56:59], v[52:55], v[188:191], v[56:59]
  v_and_b32 v48, v8, v36
  v_and_b32 v49, v9, v36
  v_and_b32 v50, v10, v36
  v_and_b32 v51, v11, v36
  s_nop 1
  v_mfma_f32_16x16x32_bf16 v[56:59], v[48:51], v[192:195], v[56:59]
  v_and_b32 v52, v8, v37
  v_and_b32 v53, v9, v37
  v_and_b32 v54, v10, v37
  v_and_b32 v55, v11, v37
  s_nop 1
  v_mfma_f32_16x16x32_bf16 v[56:59], v[52:55], v[196:199], v[56:59]
  v_and_b32 v48, v8, v38
  v_and_b32 v49, v9, v38
  v_and_b32 v50, v10, v38
  v_and_b32 v51, v11, v38
  s_nop 1
  v_mfma_f32_16x16x32_bf16 v[56:59], v[48:51], v[200:203], v[56:59]
  v_and_b32 v52, v8, v39
  v_and_b32 v53, v9, v39
  v_and_b32 v54, v10, v39
  v_and_b32 v55, v11, v39
  s_nop 1
  v_mfma_f32_16x16x32_bf16 v[56:59], v[52:55], v[204:207], v[56:59]
  v_and_b32 v48, v8, v40
  v_and_b32 v49, v9, v40
  v_and_b32 v50, v10, v40
  v_and_b32 v51, v11, v40
  s_nop 1
  v_mfma_f32_16x16x32_bf16 v[56:59], v[48:51], v[208:211], v[56:59]
  v_and_b32 v52, v8, v41
  v_and_b32 v53, v9, v41
  v_and_b32 v54, v10, v41
  v_and_b32 v55, v11, v41
  s_nop 1
  v_mfma_f32_16x16x32_bf16 v[56:59], v[52:55], v[212:215], v[56:59]
  v_and_b32 v48, v8, v42
  v_and_b32 v49, v9, v42
  v_and_b32 v50, v10, v42
  v_and_b32 v51, v11, v42
  s_nop 1
  v_mfma_f32_16x16x32_bf16 v[56:59], v[48:51], v[216:219], v[56:59]
  v_and_b32 v52, v8, v43
  v_and_b32 v53, v9, v43
  v_and_b32 v54, v10, v43
  v_and_b32 v55, v11, v43
  s_nop 1
  v_mfma_f32_16x16x32_bf16 v[56:59], v[52:55], v[220:223], v[56:59]
  v_and_b32 v48, v8, v44
  v_and_b32 v49, v9, v44
  v_and_b32 v50, v10, v44
  v_and_b32 v51, v11, v44
  s_nop 1
  v_mfma_f32_16x16x32_bf16 v[56:59], v[48:51], v[224:227], v[56:59]
  v_and_b32 v52, v8, v45
  v_and_b32 v53, v9, v45
  v_and_b32 v54, v10, v45
  v_and_b32 v55, v11, v45
  s_nop 1
  v_mfma_f32_16x16x32_bf16 v[56:59], v[52:55], v[228:231], v[56:59]
  s_add_u32 s31, s30, 401408
  buffer_load_dwordx4 v[176:179], v2, s[24:27], s31 offen nt
  s_add_u32 s31, s30, 430080
  buffer_load_dwordx4 v[180:183], v2, s[24:27], s31 offen nt
  s_add_u32 s31, s30, 458752
  buffer_load_dwordx4 v[184:187], v2, s[24:27], s31 offen nt
  s_add_u32 s31, s30, 487424
  buffer_load_dwordx4 v[188:191], v2, s[24:27], s31 offen nt
  s_add_u32 s31, s30, 516096
  buffer_load_dwordx4 v[192:195], v2, s[24:27], s31 offen nt
  s_add_u32 s31, s30, 544768
  buffer_load_dwordx4 v[196:199], v2, s[24:27], s31 offen nt
  s_add_u32 s31, s30, 573440
  buffer_load_dwordx4 v[200:203], v2, s[24:27], s31 offen nt
  s_add_u32 s31, s30, 602112
  buffer_load_dwordx4 v[204:207], v2, s[24:27], s31 offen nt
  s_add_u32 s31, s30, 630784
  buffer_load_dwordx4 v[208:211], v2, s[24:27], s31 offen nt
  s_add_u32 s31, s30, 659456
  buffer_load_dwordx4 v[212:215], v2, s[24:27], s31 offen nt
  s_add_u32 s31, s30, 688128
  buffer_load_dwordx4 v[216:219], v2, s[24:27], s31 offen nt
  s_add_u32 s31, s30, 716800
  buffer_load_dwordx4 v[220:223], v2, s[24:27], s31 offen nt
  s_add_u32 s31, s30, 745472
  buffer_load_dwordx4 v[224:227], v2, s[24:27], s31 offen nt
  s_add_u32 s31, s30, 774144
  buffer_load_dwordx4 v[228:231], v2, s[24:27], s31 offen nt
  ds_read_b32 v32, v3 offset:15936
  ds_read_b32 v33, v3 offset:15968
  ds_read_b32 v34, v3 offset:16000
  ds_read_b32 v35, v3 offset:16032
  ds_read_b32 v36, v3 offset:16064
  ds_read_b32 v37, v3 offset:16096
  ds_read_b32 v38, v3 offset:16128
  ds_read_b32 v39, v3 offset:16160
  ds_read_b32 v40, v3 offset:16192
  ds_read_b32 v41, v3 offset:16224
  ds_read_b32 v42, v3 offset:16256
  ds_read_b32 v43, v3 offset:16288
  ds_read_b32 v44, v3 offset:16320
  ds_read_b32 v45, v3 offset:16352
  s_waitcnt vmcnt(28) lgkmcnt(0)
  v_and_b32 v48, v8, v32
  v_and_b32 v49, v9, v32
  v_and_b32 v50, v10, v32
  v_and_b32 v51, v11, v32
  s_nop 1
  v_mfma_f32_16x16x32_bf16 v[56:59], v[48:51], v[64:67], v[56:59]
  v_and_b32 v52, v8, v33
  v_and_b32 v53, v9, v33
  v_and_b32 v54, v10, v33
  v_and_b32 v55, v11, v33
  s_nop 1
  v_mfma_f32_16x16x32_bf16 v[56:59], v[52:55], v[68:71], v[56:59]
  v_and_b32 v48, v8, v34
  v_and_b32 v49, v9, v34
  v_and_b32 v50, v10, v34
  v_and_b32 v51, v11, v34
  s_nop 1
  v_mfma_f32_16x16x32_bf16 v[56:59], v[48:51], v[72:75], v[56:59]
  v_and_b32 v52, v8, v35
  v_and_b32 v53, v9, v35
  v_and_b32 v54, v10, v35
  v_and_b32 v55, v11, v35
  s_nop 1
  v_mfma_f32_16x16x32_bf16 v[56:59], v[52:55], v[76:79], v[56:59]
  v_and_b32 v48, v8, v36
  v_and_b32 v49, v9, v36
  v_and_b32 v50, v10, v36
  v_and_b32 v51, v11, v36
  s_nop 1
  v_mfma_f32_16x16x32_bf16 v[56:59], v[48:51], v[80:83], v[56:59]
  v_and_b32 v52, v8, v37
  v_and_b32 v53, v9, v37
  v_and_b32 v54, v10, v37
  v_and_b32 v55, v11, v37
  s_nop 1
  v_mfma_f32_16x16x32_bf16 v[56:59], v[52:55], v[84:87], v[56:59]
  v_and_b32 v48, v8, v38
  v_and_b32 v49, v9, v38
  v_and_b32 v50, v10, v38
  v_and_b32 v51, v11, v38
  s_nop 1
  v_mfma_f32_16x16x32_bf16 v[56:59], v[48:51], v[88:91], v[56:59]
  v_and_b32 v52, v8, v39
  v_and_b32 v53, v9, v39
  v_and_b32 v54, v10, v39
  v_and_b32 v55, v11, v39
  s_nop 1
  v_mfma_f32_16x16x32_bf16 v[56:59], v[52:55], v[92:95], v[56:59]
  v_and_b32 v48, v8, v40
  v_and_b32 v49, v9, v40
  v_and_b32 v50, v10, v40
  v_and_b32 v51, v11, v40
  s_nop 1
  v_mfma_f32_16x16x32_bf16 v[56:59], v[48:51], v[96:99], v[56:59]
  v_and_b32 v52, v8, v41
  v_and_b32 v53, v9, v41
  v_and_b32 v54, v10, v41
  v_and_b32 v55, v11, v41
  s_nop 1
  v_mfma_f32_16x16x32_bf16 v[56:59], v[52:55], v[100:103], v[56:59]
  v_and_b32 v48, v8, v42
  v_and_b32 v49, v9, v42
  v_and_b32 v50, v10, v42
  v_and_b32 v51, v11, v42
  s_nop 1
  v_mfma_f32_16x16x32_bf16 v[56:59], v[48:51], v[104:107], v[56:59]
  v_and_b32 v52, v8, v43
  v_and_b32 v53, v9, v43
  v_and_b32 v54, v10, v43
  v_and_b32 v55, v11, v43
  s_nop 1
  v_mfma_f32_16x16x32_bf16 v[56:59], v[52:55], v[108:111], v[56:59]
  v_and_b32 v48, v8, v44
  v_and_b32 v49, v9, v44
  v_and_b32 v50, v10, v44
  v_and_b32 v51, v11, v44
  s_nop 1
  v_mfma_f32_16x16x32_bf16 v[56:59], v[48:51], v[112:115], v[56:59]
  v_and_b32 v52, v8, v45
  v_and_b32 v53, v9, v45
  v_and_b32 v54, v10, v45
  v_and_b32 v55, v11, v45
  s_nop 1
  v_mfma_f32_16x16x32_bf16 v[56:59], v[52:55], v[116:119], v[56:59]
  s_add_u32 s31, s30, 802816
  buffer_load_dwordx4 v[64:67], v2, s[24:27], s31 offen nt
  s_add_u32 s31, s30, 831488
  buffer_load_dwordx4 v[68:71], v2, s[24:27], s31 offen nt
  s_add_u32 s31, s30, 860160
  buffer_load_dwordx4 v[72:75], v2, s[24:27], s31 offen nt
  s_add_u32 s31, s30, 888832
  buffer_load_dwordx4 v[76:79], v2, s[24:27], s31 offen nt
  s_add_u32 s31, s30, 917504
  buffer_load_dwordx4 v[80:83], v2, s[24:27], s31 offen nt
  s_add_u32 s31, s30, 946176
  buffer_load_dwordx4 v[84:87], v2, s[24:27], s31 offen nt
  s_add_u32 s31, s30, 974848
  buffer_load_dwordx4 v[88:91], v2, s[24:27], s31 offen nt
  s_add_u32 s31, s30, 1003520
  buffer_load_dwordx4 v[92:95], v2, s[24:27], s31 offen nt
  s_add_u32 s31, s30, 1032192
  buffer_load_dwordx4 v[96:99], v2, s[24:27], s31 offen nt
  s_add_u32 s31, s30, 1060864
  buffer_load_dwordx4 v[100:103], v2, s[24:27], s31 offen nt
  s_add_u32 s31, s30, 1089536
  buffer_load_dwordx4 v[104:107], v2, s[24:27], s31 offen nt
  s_add_u32 s31, s30, 1118208
  buffer_load_dwordx4 v[108:111], v2, s[24:27], s31 offen nt
  s_add_u32 s31, s30, 1146880
  buffer_load_dwordx4 v[112:115], v2, s[24:27], s31 offen nt
  s_add_u32 s31, s30, 1175552
  buffer_load_dwordx4 v[116:119], v2, s[24:27], s31 offen nt
  ds_read_b32 v32, v3 offset:14592
  ds_read_b32 v33, v3 offset:14624
  ds_read_b32 v34, v3 offset:14656
  ds_read_b32 v35, v3 offset:14688
  ds_read_b32 v36, v3 offset:14720
  ds_read_b32 v37, v3 offset:14752
  ds_read_b32 v38, v3 offset:14784
  ds_read_b32 v39, v3 offset:14816
  ds_read_b32 v40, v3 offset:14848
  ds_read_b32 v41, v3 offset:14880
  ds_read_b32 v42, v3 offset:14912
  ds_read_b32 v43, v3 offset:14944
  ds_read_b32 v44, v3 offset:14976
  ds_read_b32 v45, v3 offset:15008
  s_waitcnt vmcnt(28) lgkmcnt(0)
  v_and_b32 v48, v8, v32
  v_and_b32 v49, v9, v32
  v_and_b32 v50, v10, v32
  v_and_b32 v51, v11, v32
  s_nop 1
  v_mfma_f32_16x16x32_bf16 v[60:63], v[48:51], v[120:123], 0
  v_and_b32 v52, v8, v33
  v_and_b32 v53, v9, v33
  v_and_b32 v54, v10, v33
  v_and_b32 v55, v11, v33
  s_nop 1
  v_mfma_f32_16x16x32_bf16 v[60:63], v[52:55], v[124:127], v[60:63]
  v_and_b32 v48, v8, v34
  v_and_b32 v49, v9, v34
  v_and_b32 v50, v10, v34
  v_and_b32 v51, v11, v34
  s_nop 1
  v_mfma_f32_16x16x32_bf16 v[60:63], v[48:51], v[128:131], v[60:63]
  v_and_b32 v52, v8, v35
  v_and_b32 v53, v9, v35
  v_and_b32 v54, v10, v35
  v_and_b32 v55, v11, v35
  s_nop 1
  v_mfma_f32_16x16x32_bf16 v[60:63], v[52:55], v[132:135], v[60:63]
  v_and_b32 v48, v8, v36
  v_and_b32 v49, v9, v36
  v_and_b32 v50, v10, v36
  v_and_b32 v51, v11, v36
  s_nop 1
  v_mfma_f32_16x16x32_bf16 v[60:63], v[48:51], v[136:139], v[60:63]
  v_and_b32 v52, v8, v37
  v_and_b32 v53, v9, v37
  v_and_b32 v54, v10, v37
  v_and_b32 v55, v11, v37
  s_nop 1
  v_mfma_f32_16x16x32_bf16 v[60:63], v[52:55], v[140:143], v[60:63]
  v_and_b32 v48, v8, v38
  v_and_b32 v49, v9, v38
  v_and_b32 v50, v10, v38
  v_and_b32 v51, v11, v38
  s_nop 1
  v_mfma_f32_16x16x32_bf16 v[60:63], v[48:51], v[144:147], v[60:63]
  v_and_b32 v52, v8, v39
  v_and_b32 v53, v9, v39
  v_and_b32 v54, v10, v39
  v_and_b32 v55, v11, v39
  s_nop 1
  v_mfma_f32_16x16x32_bf16 v[60:63], v[52:55], v[148:151], v[60:63]
  v_and_b32 v48, v8, v40
  v_and_b32 v49, v9, v40
  v_and_b32 v50, v10, v40
  v_and_b32 v51, v11, v40
  s_nop 1
  v_mfma_f32_16x16x32_bf16 v[60:63], v[48:51], v[152:155], v[60:63]
  v_and_b32 v52, v8, v41
  v_and_b32 v53, v9, v41
  v_and_b32 v54, v10, v41
  v_and_b32 v55, v11, v41
  s_nop 1
  v_mfma_f32_16x16x32_bf16 v[60:63], v[52:55], v[156:159], v[60:63]
  v_and_b32 v48, v8, v42
  v_and_b32 v49, v9, v42
  v_and_b32 v50, v10, v42
  v_and_b32 v51, v11, v42
  s_nop 1
  v_mfma_f32_16x16x32_bf16 v[60:63], v[48:51], v[160:163], v[60:63]
  v_and_b32 v52, v8, v43
  v_and_b32 v53, v9, v43
  v_and_b32 v54, v10, v43
  v_and_b32 v55, v11, v43
  s_nop 1
  v_mfma_f32_16x16x32_bf16 v[60:63], v[52:55], v[164:167], v[60:63]
  v_and_b32 v48, v8, v44
  v_and_b32 v49, v9, v44
  v_and_b32 v50, v10, v44
  v_and_b32 v51, v11, v44
  s_nop 1
  v_mfma_f32_16x16x32_bf16 v[60:63], v[48:51], v[168:171], v[60:63]
  v_and_b32 v52, v8, v45
  v_and_b32 v53, v9, v45
  v_and_b32 v54, v10, v45
  v_and_b32 v55, v11, v45
  s_nop 1
  v_mfma_f32_16x16x32_bf16 v[60:63], v[52:55], v[172:175], v[60:63]
  s_add_u32 s31, s30, 1204224
  buffer_load_dwordx4 v[120:123], v2, s[24:27], s31 offen nt
  s_add_u32 s31, s30, 1232896
  buffer_load_dwordx4 v[124:127], v2, s[24:27], s31 offen nt
  s_add_u32 s31, s30, 1261568
  buffer_load_dwordx4 v[128:131], v2, s[24:27], s31 offen nt
  s_add_u32 s31, s30, 1290240
  buffer_load_dwordx4 v[132:135], v2, s[24:27], s31 offen nt
  s_add_u32 s31, s30, 1318912
  buffer_load_dwordx4 v[136:139], v2, s[24:27], s31 offen nt
  s_add_u32 s31, s30, 1347584
  buffer_load_dwordx4 v[140:143], v2, s[24:27], s31 offen nt
  s_add_u32 s31, s30, 1376256
  buffer_load_dwordx4 v[144:147], v2, s[24:27], s31 offen nt
  s_add_u32 s31, s30, 1404928
  buffer_load_dwordx4 v[148:151], v2, s[24:27], s31 offen nt
  s_add_u32 s31, s30, 1433600
  buffer_load_dwordx4 v[152:155], v2, s[24:27], s31 offen nt
  s_add_u32 s31, s30, 1462272
  buffer_load_dwordx4 v[156:159], v2, s[24:27], s31 offen nt
  s_add_u32 s31, s30, 1490944
  buffer_load_dwordx4 v[160:163], v2, s[24:27], s31 offen nt
  s_add_u32 s31, s30, 1519616
  buffer_load_dwordx4 v[164:167], v2, s[24:27], s31 offen nt
  s_add_u32 s31, s30, 1548288
  buffer_load_dwordx4 v[168:171], v2, s[24:27], s31 offen nt
  s_add_u32 s31, s30, 1576960
  buffer_load_dwordx4 v[172:175], v2, s[24:27], s31 offen nt
  ds_read_b32 v32, v3 offset:15040
  ds_read_b32 v33, v3 offset:15072
  ds_read_b32 v34, v3 offset:15104
  ds_read_b32 v35, v3 offset:15136
  ds_read_b32 v36, v3 offset:15168
  ds_read_b32 v37, v3 offset:15200
  ds_read_b32 v38, v3 offset:15232
  ds_read_b32 v39, v3 offset:15264
  ds_read_b32 v40, v3 offset:15296
  ds_read_b32 v41, v3 offset:15328
  ds_read_b32 v42, v3 offset:15360
  ds_read_b32 v43, v3 offset:15392
  ds_read_b32 v44, v3 offset:15424
  ds_read_b32 v45, v3 offset:15456
  s_waitcnt vmcnt(28) lgkmcnt(0)
  v_and_b32 v48, v8, v32
  v_and_b32 v49, v9, v32
  v_and_b32 v50, v10, v32
  v_and_b32 v51, v11, v32
  s_nop 1
  v_mfma_f32_16x16x32_bf16 v[60:63], v[48:51], v[176:179], v[60:63]
  v_and_b32 v52, v8, v33
  v_and_b32 v53, v9, v33
  v_and_b32 v54, v10, v33
  v_and_b32 v55, v11, v33
  s_nop 1
  v_mfma_f32_16x16x32_bf16 v[60:63], v[52:55], v[180:183], v[60:63]
  v_and_b32 v48, v8, v34
  v_and_b32 v49, v9, v34
  v_and_b32 v50, v10, v34
  v_and_b32 v51, v11, v34
  s_nop 1
  v_mfma_f32_16x16x32_bf16 v[60:63], v[48:51], v[184:187], v[60:63]
  v_and_b32 v52, v8, v35
  v_and_b32 v53, v9, v35
  v_and_b32 v54, v10, v35
  v_and_b32 v55, v11, v35
  s_nop 1
  v_mfma_f32_16x16x32_bf16 v[60:63], v[52:55], v[188:191], v[60:63]
  v_and_b32 v48, v8, v36
  v_and_b32 v49, v9, v36
  v_and_b32 v50, v10, v36
  v_and_b32 v51, v11, v36
  s_nop 1
  v_mfma_f32_16x16x32_bf16 v[60:63], v[48:51], v[192:195], v[60:63]
  v_and_b32 v52, v8, v37
  v_and_b32 v53, v9, v37
  v_and_b32 v54, v10, v37
  v_and_b32 v55, v11, v37
  s_nop 1
  v_mfma_f32_16x16x32_bf16 v[60:63], v[52:55], v[196:199], v[60:63]
  v_and_b32 v48, v8, v38
  v_and_b32 v49, v9, v38
  v_and_b32 v50, v10, v38
  v_and_b32 v51, v11, v38
  s_nop 1
  v_mfma_f32_16x16x32_bf16 v[60:63], v[48:51], v[200:203], v[60:63]
  v_and_b32 v52, v8, v39
  v_and_b32 v53, v9, v39
  v_and_b32 v54, v10, v39
  v_and_b32 v55, v11, v39
  s_nop 1
  v_mfma_f32_16x16x32_bf16 v[60:63], v[52:55], v[204:207], v[60:63]
  v_and_b32 v48, v8, v40
  v_and_b32 v49, v9, v40
  v_and_b32 v50, v10, v40
  v_and_b32 v51, v11, v40
  s_nop 1
  v_mfma_f32_16x16x32_bf16 v[60:63], v[48:51], v[208:211], v[60:63]
  v_and_b32 v52, v8, v41
  v_and_b32 v53, v9, v41
  v_and_b32 v54, v10, v41
  v_and_b32 v55, v11, v41
  s_nop 1
  v_mfma_f32_16x16x32_bf16 v[60:63], v[52:55], v[212:215], v[60:63]
  v_and_b32 v48, v8, v42
  v_and_b32 v49, v9, v42
  v_and_b32 v50, v10, v42
  v_and_b32 v51, v11, v42
  s_nop 1
  v_mfma_f32_16x16x32_bf16 v[60:63], v[48:51], v[216:219], v[60:63]
  v_and_b32 v52, v8, v43
  v_and_b32 v53, v9, v43
  v_and_b32 v54, v10, v43
  v_and_b32 v55, v11, v43
  s_nop 1
  v_mfma_f32_16x16x32_bf16 v[60:63], v[52:55], v[220:223], v[60:63]
  v_and_b32 v48, v8, v44
  v_and_b32 v49, v9, v44
  v_and_b32 v50, v10, v44
  v_and_b32 v51, v11, v44
  s_nop 1
  v_mfma_f32_16x16x32_bf16 v[60:63], v[48:51], v[224:227], v[60:63]
  v_and_b32 v52, v8, v45
  v_and_b32 v53, v9, v45
  v_and_b32 v54, v10, v45
  v_and_b32 v55, v11, v45
  s_nop 1
  v_mfma_f32_16x16x32_bf16 v[60:63], v[52:55], v[228:231], v[60:63]
  ds_read_b32 v32, v3 offset:15488
  ds_read_b32 v33, v3 offset:15520
  ds_read_b32 v34, v3 offset:15552
  ds_read_b32 v35, v3 offset:15584
  ds_read_b32 v36, v3 offset:15616
  ds_read_b32 v37, v3 offset:15648
  ds_read_b32 v38, v3 offset:15680
  ds_read_b32 v39, v3 offset:15712
  ds_read_b32 v40, v3 offset:15744
  ds_read_b32 v41, v3 offset:15776
  ds_read_b32 v42, v3 offset:15808
  ds_read_b32 v43, v3 offset:15840
  ds_read_b32 v44, v3 offset:15872
  ds_read_b32 v45, v3 offset:15904
  s_waitcnt vmcnt(14) lgkmcnt(0)
  v_and_b32 v48, v8, v32
  v_and_b32 v49, v9, v32
  v_and_b32 v50, v10, v32
  v_and_b32 v51, v11, v32
  s_nop 1
  v_mfma_f32_16x16x32_bf16 v[60:63], v[48:51], v[64:67], v[60:63]
  v_and_b32 v52, v8, v33
  v_and_b32 v53, v9, v33
  v_and_b32 v54, v10, v33
  v_and_b32 v55, v11, v33
  s_nop 1
  v_mfma_f32_16x16x32_bf16 v[60:63], v[52:55], v[68:71], v[60:63]
  v_and_b32 v48, v8, v34
  v_and_b32 v49, v9, v34
  v_and_b32 v50, v10, v34
  v_and_b32 v51, v11, v34
  s_nop 1
  v_mfma_f32_16x16x32_bf16 v[60:63], v[48:51], v[72:75], v[60:63]
  v_and_b32 v52, v8, v35
  v_and_b32 v53, v9, v35
  v_and_b32 v54, v10, v35
  v_and_b32 v55, v11, v35
  s_nop 1
  v_mfma_f32_16x16x32_bf16 v[60:63], v[52:55], v[76:79], v[60:63]
  v_and_b32 v48, v8, v36
  v_and_b32 v49, v9, v36
  v_and_b32 v50, v10, v36
  v_and_b32 v51, v11, v36
  s_nop 1
  v_mfma_f32_16x16x32_bf16 v[60:63], v[48:51], v[80:83], v[60:63]
  v_and_b32 v52, v8, v37
  v_and_b32 v53, v9, v37
  v_and_b32 v54, v10, v37
  v_and_b32 v55, v11, v37
  s_nop 1
  v_mfma_f32_16x16x32_bf16 v[60:63], v[52:55], v[84:87], v[60:63]
  v_and_b32 v48, v8, v38
  v_and_b32 v49, v9, v38
  v_and_b32 v50, v10, v38
  v_and_b32 v51, v11, v38
  s_nop 1
  v_mfma_f32_16x16x32_bf16 v[60:63], v[48:51], v[88:91], v[60:63]
  v_and_b32 v52, v8, v39
  v_and_b32 v53, v9, v39
  v_and_b32 v54, v10, v39
  v_and_b32 v55, v11, v39
  s_nop 1
  v_mfma_f32_16x16x32_bf16 v[60:63], v[52:55], v[92:95], v[60:63]
  v_and_b32 v48, v8, v40
  v_and_b32 v49, v9, v40
  v_and_b32 v50, v10, v40
  v_and_b32 v51, v11, v40
  s_nop 1
  v_mfma_f32_16x16x32_bf16 v[60:63], v[48:51], v[96:99], v[60:63]
  v_and_b32 v52, v8, v41
  v_and_b32 v53, v9, v41
  v_and_b32 v54, v10, v41
  v_and_b32 v55, v11, v41
  s_nop 1
  v_mfma_f32_16x16x32_bf16 v[60:63], v[52:55], v[100:103], v[60:63]
  v_and_b32 v48, v8, v42
  v_and_b32 v49, v9, v42
  v_and_b32 v50, v10, v42
  v_and_b32 v51, v11, v42
  s_nop 1
  v_mfma_f32_16x16x32_bf16 v[60:63], v[48:51], v[104:107], v[60:63]
  v_and_b32 v52, v8, v43
  v_and_b32 v53, v9, v43
  v_and_b32 v54, v10, v43
  v_and_b32 v55, v11, v43
  s_nop 1
  v_mfma_f32_16x16x32_bf16 v[60:63], v[52:55], v[108:111], v[60:63]
  v_and_b32 v48, v8, v44
  v_and_b32 v49, v9, v44
  v_and_b32 v50, v10, v44
  v_and_b32 v51, v11, v44
  s_nop 1
  v_mfma_f32_16x16x32_bf16 v[60:63], v[48:51], v[112:115], v[60:63]
  v_and_b32 v52, v8, v45
  v_and_b32 v53, v9, v45
  v_and_b32 v54, v10, v45
  v_and_b32 v55, v11, v45
  s_nop 1
  v_mfma_f32_16x16x32_bf16 v[60:63], v[52:55], v[116:119], v[60:63]
  ds_read_b32 v32, v3 offset:15936
  ds_read_b32 v33, v3 offset:15968
  ds_read_b32 v34, v3 offset:16000
  ds_read_b32 v35, v3 offset:16032
  ds_read_b32 v36, v3 offset:16064
  ds_read_b32 v37, v3 offset:16096
  ds_read_b32 v38, v3 offset:16128
  ds_read_b32 v39, v3 offset:16160
  ds_read_b32 v40, v3 offset:16192
  ds_read_b32 v41, v3 offset:16224
  ds_read_b32 v42, v3 offset:16256
  ds_read_b32 v43, v3 offset:16288
  ds_read_b32 v44, v3 offset:16320
  ds_read_b32 v45, v3 offset:16352
  s_waitcnt vmcnt(0) lgkmcnt(0)
  v_and_b32 v48, v8, v32
  v_and_b32 v49, v9, v32
  v_and_b32 v50, v10, v32
  v_and_b32 v51, v11, v32
  s_nop 1
  v_mfma_f32_16x16x32_bf16 v[60:63], v[48:51], v[120:123], v[60:63]
  v_and_b32 v52, v8, v33
  v_and_b32 v53, v9, v33
  v_and_b32 v54, v10, v33
  v_and_b32 v55, v11, v33
  s_nop 1
  v_mfma_f32_16x16x32_bf16 v[60:63], v[52:55], v[124:127], v[60:63]
  v_and_b32 v48, v8, v34
  v_and_b32 v49, v9, v34
  v_and_b32 v50, v10, v34
  v_and_b32 v51, v11, v34
  s_nop 1
  v_mfma_f32_16x16x32_bf16 v[60:63], v[48:51], v[128:131], v[60:63]
  v_and_b32 v52, v8, v35
  v_and_b32 v53, v9, v35
  v_and_b32 v54, v10, v35
  v_and_b32 v55, v11, v35
  s_nop 1
  v_mfma_f32_16x16x32_bf16 v[60:63], v[52:55], v[132:135], v[60:63]
  v_and_b32 v48, v8, v36
  v_and_b32 v49, v9, v36
  v_and_b32 v50, v10, v36
  v_and_b32 v51, v11, v36
  s_nop 1
  v_mfma_f32_16x16x32_bf16 v[60:63], v[48:51], v[136:139], v[60:63]
  v_and_b32 v52, v8, v37
  v_and_b32 v53, v9, v37
  v_and_b32 v54, v10, v37
  v_and_b32 v55, v11, v37
  s_nop 1
  v_mfma_f32_16x16x32_bf16 v[60:63], v[52:55], v[140:143], v[60:63]
  v_and_b32 v48, v8, v38
  v_and_b32 v49, v9, v38
  v_and_b32 v50, v10, v38
  v_and_b32 v51, v11, v38
  s_nop 1
  v_mfma_f32_16x16x32_bf16 v[60:63], v[48:51], v[144:147], v[60:63]
  v_and_b32 v52, v8, v39
  v_and_b32 v53, v9, v39
  v_and_b32 v54, v10, v39
  v_and_b32 v55, v11, v39
  s_nop 1
  v_mfma_f32_16x16x32_bf16 v[60:63], v[52:55], v[148:151], v[60:63]
  v_and_b32 v48, v8, v40
  v_and_b32 v49, v9, v40
  v_and_b32 v50, v10, v40
  v_and_b32 v51, v11, v40
  s_nop 1
  v_mfma_f32_16x16x32_bf16 v[60:63], v[48:51], v[152:155], v[60:63]
  v_and_b32 v52, v8, v41
  v_and_b32 v53, v9, v41
  v_and_b32 v54, v10, v41
  v_and_b32 v55, v11, v41
  s_nop 1
  v_mfma_f32_16x16x32_bf16 v[60:63], v[52:55], v[156:159], v[60:63]
  v_and_b32 v48, v8, v42
  v_and_b32 v49, v9, v42
  v_and_b32 v50, v10, v42
  v_and_b32 v51, v11, v42
  s_nop 1
  v_mfma_f32_16x16x32_bf16 v[60:63], v[48:51], v[160:163], v[60:63]
  v_and_b32 v52, v8, v43
  v_and_b32 v53, v9, v43
  v_and_b32 v54, v10, v43
  v_and_b32 v55, v11, v43
  s_nop 1
  v_mfma_f32_16x16x32_bf16 v[60:63], v[52:55], v[164:167], v[60:63]
  v_and_b32 v48, v8, v44
  v_and_b32 v49, v9, v44
  v_and_b32 v50, v10, v44
  v_and_b32 v51, v11, v44
  s_nop 1
  v_mfma_f32_16x16x32_bf16 v[60:63], v[48:51], v[168:171], v[60:63]
  v_and_b32 v52, v8, v45
  v_and_b32 v53, v9, v45
  v_and_b32 v54, v10, v45
  v_and_b32 v55, v11, v45
  s_nop 1
  v_mfma_f32_16x16x32_bf16 v[60:63], v[52:55], v[172:175], v[60:63]
  s_mov_b32 s20, s52
  s_and_b32 s21, s53, 0xffff
  s_mov_b32 s22, 1605632
  s_mov_b32 s23, 0x00020000
  v_and_b32 v4, 15, v0
  v_lshrrev_b32 v5, 4, v0
  v_mul_u32_u24 v6, 896, v5
  v_lshl_add_u32 v6, v4, 4, v6
  s_lshl_b32 s30, s33, 6
  s_mul_i32 s30, s30, 896
  s_add_u32 s31, s30, 0
  buffer_load_dwordx4 v[64:67], v6, s[20:23], s31 offen offset:0 nt
  buffer_load_dwordx4 v[68:71], v6, s[20:23], s31 offen offset:256 nt
  buffer_load_dwordx4 v[72:75], v6, s[20:23], s31 offen offset:512 nt
  buffer_load_dwordx4 v[76:79], v6, s[20:23], s31 offen offset:768 nt
  s_add_u32 s31, s30, 3584
  buffer_load_dwordx4 v[80:83], v6, s[20:23], s31 offen offset:0 nt
  buffer_load_dwordx4 v[84:87], v6, s[20:23], s31 offen offset:256 nt
  buffer_load_dwordx4 v[88:91], v6, s[20:23], s31 offen offset:512 nt
  buffer_load_dwordx4 v[92:95], v6, s[20:23], s31 offen offset:768 nt
  s_add_u32 s31, s30, 7168
  buffer_load_dwordx4 v[96:99], v6, s[20:23], s31 offen offset:0 nt
  buffer_load_dwordx4 v[100:103], v6, s[20:23], s31 offen offset:256 nt
  buffer_load_dwordx4 v[104:107], v6, s[20:23], s31 offen offset:512 nt
  buffer_load_dwordx4 v[108:111], v6, s[20:23], s31 offen offset:768 nt
  s_add_u32 s31, s30, 10752
  buffer_load_dwordx4 v[112:115], v6, s[20:23], s31 offen offset:0 nt
  buffer_load_dwordx4 v[116:119], v6, s[20:23], s31 offen offset:256 nt
  buffer_load_dwordx4 v[120:123], v6, s[20:23], s31 offen offset:512 nt
  buffer_load_dwordx4 v[124:127], v6, s[20:23], s31 offen offset:768 nt
  s_add_u32 s31, s30, 14336
  buffer_load_dwordx4 v[128:131], v6, s[20:23], s31 offen offset:0 nt
  buffer_load_dwordx4 v[132:135], v6, s[20:23], s31 offen offset:256 nt
  buffer_load_dwordx4 v[136:139], v6, s[20:23], s31 offen offset:512 nt
  buffer_load_dwordx4 v[140:143], v6, s[20:23], s31 offen offset:768 nt
  s_add_u32 s31, s30, 17920
  buffer_load_dwordx4 v[144:147], v6, s[20:23], s31 offen offset:0 nt
  buffer_load_dwordx4 v[148:151], v6, s[20:23], s31 offen offset:256 nt
  buffer_load_dwordx4 v[152:155], v6, s[20:23], s31 offen offset:512 nt
  buffer_load_dwordx4 v[156:159], v6, s[20:23], s31 offen offset:768 nt
  s_add_u32 s31, s30, 21504
  buffer_load_dwordx4 v[160:163], v6, s[20:23], s31 offen offset:0 nt
  buffer_load_dwordx4 v[164:167], v6, s[20:23], s31 offen offset:256 nt
  buffer_load_dwordx4 v[168:171], v6, s[20:23], s31 offen offset:512 nt
  buffer_load_dwordx4 v[172:175], v6, s[20:23], s31 offen offset:768 nt
  s_add_u32 s31, s30, 25088
  buffer_load_dwordx4 v[176:179], v6, s[20:23], s31 offen offset:0 nt
  buffer_load_dwordx4 v[180:183], v6, s[20:23], s31 offen offset:256 nt
  buffer_load_dwordx4 v[184:187], v6, s[20:23], s31 offen offset:512 nt
  buffer_load_dwordx4 v[188:191], v6, s[20:23], s31 offen offset:768 nt
  s_add_u32 s31, s30, 28672
  buffer_load_dwordx4 v[192:195], v6, s[20:23], s31 offen offset:0 nt
  buffer_load_dwordx4 v[196:199], v6, s[20:23], s31 offen offset:256 nt
  buffer_load_dwordx4 v[200:203], v6, s[20:23], s31 offen offset:512 nt
  buffer_load_dwordx4 v[204:207], v6, s[20:23], s31 offen offset:768 nt
  s_add_u32 s31, s30, 32256
  buffer_load_dwordx4 v[208:211], v6, s[20:23], s31 offen offset:0 nt
  buffer_load_dwordx4 v[212:215], v6, s[20:23], s31 offen offset:256 nt
  buffer_load_dwordx4 v[216:219], v6, s[20:23], s31 offen offset:512 nt
  buffer_load_dwordx4 v[220:223], v6, s[20:23], s31 offen offset:768 nt
  s_add_u32 s31, s30, 35840
  buffer_load_dwordx4 v[224:227], v6, s[20:23], s31 offen offset:0 nt
  buffer_load_dwordx4 v[228:231], v6, s[20:23], s31 offen offset:256 nt
  buffer_load_dwordx4 v[232:235], v6, s[20:23], s31 offen offset:512 nt
  buffer_load_dwordx4 v[236:239], v6, s[20:23], s31 offen offset:768 nt
  s_add_u32 s31, s30, 39424
  buffer_load_dwordx4 v[240:243], v6, s[20:23], s31 offen offset:0 nt
  buffer_load_dwordx4 v[244:247], v6, s[20:23], s31 offen offset:256 nt
  buffer_load_dwordx4 v[248:251], v6, s[20:23], s31 offen offset:512 nt
  buffer_load_dwordx4 v[252:255], v6, s[20:23], s31 offen offset:768 nt
  v_lshlrev_b32 v7, 4, v0
  s_nop 3
  ds_write_b128 v7, v[56:59] offset:17664
  ds_write_b128 v7, v[60:63] offset:18688
  v_and_b32 v2, 7, v0
  v_bfe_u32 v3, v0, 3, 1
  v_lshl_add_u32 v7, v3, 4, v2
  v_lshlrev_b32 v7, 4, v7
  s_waitcnt lgkmcnt(0)
  ds_read_b128 v[32:35], v7 offset:17664
  ds_read_b128 v[36:39], v7 offset:18304
  ds_read_b128 v[40:43], v7 offset:18688
  ds_read_b128 v[44:47], v7 offset:19328
  s_waitcnt lgkmcnt(0)
  v_add_f32 v32, v32, v36
  v_add_f32 v40, v40, v44
  v_cvt_pk_bf16_f32 v32, v32, v32
  v_and_b32 v32, 0xffff0000, v32
  v_cvt_pk_bf16_f32 v40, v40, v40
  v_and_b32 v40, 0xffff0000, v40
  v_max_f32 v32, 0, v32
  v_mul_f32 v32, v32, v40
  v_cvt_pk_bf16_f32 v32, v32, v32
  v_add_f32 v33, v33, v37
  v_add_f32 v41, v41, v45
  v_cvt_pk_bf16_f32 v33, v33, v33
  v_and_b32 v33, 0xffff0000, v33
  v_cvt_pk_bf16_f32 v41, v41, v41
  v_and_b32 v41, 0xffff0000, v41
  v_max_f32 v33, 0, v33
  v_mul_f32 v33, v33, v41
  v_cvt_pk_bf16_f32 v33, v33, v33
  v_add_f32 v34, v34, v38
  v_add_f32 v42, v42, v46
  v_cvt_pk_bf16_f32 v34, v34, v34
  v_and_b32 v34, 0xffff0000, v34
  v_cvt_pk_bf16_f32 v42, v42, v42
  v_and_b32 v42, 0xffff0000, v42
  v_max_f32 v34, 0, v34
  v_mul_f32 v34, v34, v42
  v_cvt_pk_bf16_f32 v34, v34, v34
  v_add_f32 v35, v35, v39
  v_add_f32 v43, v43, v47
  v_cvt_pk_bf16_f32 v35, v35, v35
  v_and_b32 v35, 0xffff0000, v35
  v_cvt_pk_bf16_f32 v43, v43, v43
  v_and_b32 v43, 0xffff0000, v43
  v_max_f32 v35, 0, v35
  v_mul_f32 v35, v35, v43
  v_cvt_pk_bf16_f32 v35, v35, v35
  v_lshlrev_b32 v2, 5, v2
  v_lshl_add_u32 v2, v3, 4, v2
  s_mov_b32 exec_lo, 0xffff
  s_mov_b32 exec_hi, 0x0
  ds_write_b128 v2, v[32:35] offset:17408
  s_mov_b64 exec, -1
  s_waitcnt lgkmcnt(0)
  v_lshlrev_b32 v3, 2, v5
  ds_read_b32 v12, v3 offset:17408
  ds_read_b32 v13, v3 offset:17424
  ds_read_b32 v14, v3 offset:17440
  ds_read_b32 v15, v3 offset:17456
  ds_read_b32 v16, v3 offset:17472
  ds_read_b32 v17, v3 offset:17488
  ds_read_b32 v18, v3 offset:17504
  ds_read_b32 v19, v3 offset:17520
  ds_read_b32 v20, v3 offset:17536
  ds_read_b32 v21, v3 offset:17552
  ds_read_b32 v22, v3 offset:17568
  ds_read_b32 v23, v3 offset:17584
  ds_read_b32 v24, v3 offset:17600
  ds_read_b32 v25, v3 offset:17616
  ds_read_b32 v26, v3 offset:17632
  ds_read_b32 v27, v3 offset:17648
  s_waitcnt lgkmcnt(0)
  s_waitcnt vmcnt(32)
  v_and_b32 v48, v8, v12
  v_and_b32 v49, v9, v12
  v_and_b32 v50, v10, v12
  v_and_b32 v51, v11, v12
  s_nop 1
  v_mfma_f32_16x16x32_bf16 v[32:35], v[48:51], v[64:67], 0
  v_mfma_f32_16x16x32_bf16 v[36:39], v[48:51], v[68:71], 0
  v_mfma_f32_16x16x32_bf16 v[40:43], v[48:51], v[72:75], 0
  v_mfma_f32_16x16x32_bf16 v[44:47], v[48:51], v[76:79], 0
  v_and_b32 v52, v8, v13
  v_and_b32 v53, v9, v13
  v_and_b32 v54, v10, v13
  v_and_b32 v55, v11, v13
  s_nop 1
  v_mfma_f32_16x16x32_bf16 v[32:35], v[52:55], v[80:83], v[32:35]
  v_mfma_f32_16x16x32_bf16 v[36:39], v[52:55], v[84:87], v[36:39]
  v_mfma_f32_16x16x32_bf16 v[40:43], v[52:55], v[88:91], v[40:43]
  v_mfma_f32_16x16x32_bf16 v[44:47], v[52:55], v[92:95], v[44:47]
  v_and_b32 v48, v8, v14
  v_and_b32 v49, v9, v14
  v_and_b32 v50, v10, v14
  v_and_b32 v51, v11, v14
  s_nop 1
  v_mfma_f32_16x16x32_bf16 v[32:35], v[48:51], v[96:99], v[32:35]
  v_mfma_f32_16x16x32_bf16 v[36:39], v[48:51], v[100:103], v[36:39]
  v_mfma_f32_16x16x32_bf16 v[40:43], v[48:51], v[104:107], v[40:43]
  v_mfma_f32_16x16x32_bf16 v[44:47], v[48:51], v[108:111], v[44:47]
  v_and_b32 v52, v8, v15
  v_and_b32 v53, v9, v15
  v_and_b32 v54, v10, v15
  v_and_b32 v55, v11, v15
  s_nop 1
  v_mfma_f32_16x16x32_bf16 v[32:35], v[52:55], v[112:115], v[32:35]
  v_mfma_f32_16x16x32_bf16 v[36:39], v[52:55], v[116:119], v[36:39]
  v_mfma_f32_16x16x32_bf16 v[40:43], v[52:55], v[120:123], v[40:43]
  v_mfma_f32_16x16x32_bf16 v[44:47], v[52:55], v[124:127], v[44:47]
  s_add_u32 s31, s30, 43008
  buffer_load_dwordx4 v[64:67], v6, s[20:23], s31 offen offset:0 nt
  buffer_load_dwordx4 v[68:71], v6, s[20:23], s31 offen offset:256 nt
  buffer_load_dwordx4 v[72:75], v6, s[20:23], s31 offen offset:512 nt
  buffer_load_dwordx4 v[76:79], v6, s[20:23], s31 offen offset:768 nt
  s_add_u32 s31, s30, 46592
  buffer_load_dwordx4 v[80:83], v6, s[20:23], s31 offen offset:0 nt
  buffer_load_dwordx4 v[84:87], v6, s[20:23], s31 offen offset:256 nt
  buffer_load_dwordx4 v[88:91], v6, s[20:23], s31 offen offset:512 nt
  buffer_load_dwordx4 v[92:95], v6, s[20:23], s31 offen offset:768 nt
  s_add_u32 s31, s30, 50176
  buffer_load_dwordx4 v[96:99], v6, s[20:23], s31 offen offset:0 nt
  buffer_load_dwordx4 v[100:103], v6, s[20:23], s31 offen offset:256 nt
  buffer_load_dwordx4 v[104:107], v6, s[20:23], s31 offen offset:512 nt
  buffer_load_dwordx4 v[108:111], v6, s[20:23], s31 offen offset:768 nt
  s_add_u32 s31, s30, 53760
  buffer_load_dwordx4 v[112:115], v6, s[20:23], s31 offen offset:0 nt
  buffer_load_dwordx4 v[116:119], v6, s[20:23], s31 offen offset:256 nt
  buffer_load_dwordx4 v[120:123], v6, s[20:23], s31 offen offset:512 nt
  buffer_load_dwordx4 v[124:127], v6, s[20:23], s31 offen offset:768 nt
  s_waitcnt vmcnt(32)
  v_and_b32 v48, v8, v16
  v_and_b32 v49, v9, v16
  v_and_b32 v50, v10, v16
  v_and_b32 v51, v11, v16
  s_nop 1
  v_mfma_f32_16x16x32_bf16 v[32:35], v[48:51], v[128:131], v[32:35]
  v_mfma_f32_16x16x32_bf16 v[36:39], v[48:51], v[132:135], v[36:39]
  v_mfma_f32_16x16x32_bf16 v[40:43], v[48:51], v[136:139], v[40:43]
  v_mfma_f32_16x16x32_bf16 v[44:47], v[48:51], v[140:143], v[44:47]
  v_and_b32 v52, v8, v17
  v_and_b32 v53, v9, v17
  v_and_b32 v54, v10, v17
  v_and_b32 v55, v11, v17
  s_nop 1
  v_mfma_f32_16x16x32_bf16 v[32:35], v[52:55], v[144:147], v[32:35]
  v_mfma_f32_16x16x32_bf16 v[36:39], v[52:55], v[148:151], v[36:39]
  v_mfma_f32_16x16x32_bf16 v[40:43], v[52:55], v[152:155], v[40:43]
  v_mfma_f32_16x16x32_bf16 v[44:47], v[52:55], v[156:159], v[44:47]
  v_and_b32 v48, v8, v18
  v_and_b32 v49, v9, v18
  v_and_b32 v50, v10, v18
  v_and_b32 v51, v11, v18
  s_nop 1
  v_mfma_f32_16x16x32_bf16 v[32:35], v[48:51], v[160:163], v[32:35]
  v_mfma_f32_16x16x32_bf16 v[36:39], v[48:51], v[164:167], v[36:39]
  v_mfma_f32_16x16x32_bf16 v[40:43], v[48:51], v[168:171], v[40:43]
  v_mfma_f32_16x16x32_bf16 v[44:47], v[48:51], v[172:175], v[44:47]
  v_and_b32 v52, v8, v19
  v_and_b32 v53, v9, v19
  v_and_b32 v54, v10, v19
  v_and_b32 v55, v11, v19
  s_nop 1
  v_mfma_f32_16x16x32_bf16 v[32:35], v[52:55], v[176:179], v[32:35]
  v_mfma_f32_16x16x32_bf16 v[36:39], v[52:55], v[180:183], v[36:39]
  v_mfma_f32_16x16x32_bf16 v[40:43], v[52:55], v[184:187], v[40:43]
  v_mfma_f32_16x16x32_bf16 v[44:47], v[52:55], v[188:191], v[44:47]
  s_waitcnt vmcnt(16)
  v_and_b32 v48, v8, v20
  v_and_b32 v49, v9, v20
  v_and_b32 v50, v10, v20
  v_and_b32 v51, v11, v20
  s_nop 1
  v_mfma_f32_16x16x32_bf16 v[32:35], v[48:51], v[192:195], v[32:35]
  v_mfma_f32_16x16x32_bf16 v[36:39], v[48:51], v[196:199], v[36:39]
  v_mfma_f32_16x16x32_bf16 v[40:43], v[48:51], v[200:203], v[40:43]
  v_mfma_f32_16x16x32_bf16 v[44:47], v[48:51], v[204:207], v[44:47]
  v_and_b32 v52, v8, v21
  v_and_b32 v53, v9, v21
  v_and_b32 v54, v10, v21
  v_and_b32 v55, v11, v21
  s_nop 1
  v_mfma_f32_16x16x32_bf16 v[32:35], v[52:55], v[208:211], v[32:35]
  v_mfma_f32_16x16x32_bf16 v[36:39], v[52:55], v[212:215], v[36:39]
  v_mfma_f32_16x16x32_bf16 v[40:43], v[52:55], v[216:219], v[40:43]
  v_mfma_f32_16x16x32_bf16 v[44:47], v[52:55], v[220:223], v[44:47]
  v_and_b32 v48, v8, v22
  v_and_b32 v49, v9, v22
  v_and_b32 v50, v10, v22
  v_and_b32 v51, v11, v22
  s_nop 1
  v_mfma_f32_16x16x32_bf16 v[32:35], v[48:51], v[224:227], v[32:35]
  v_mfma_f32_16x16x32_bf16 v[36:39], v[48:51], v[228:231], v[36:39]
  v_mfma_f32_16x16x32_bf16 v[40:43], v[48:51], v[232:235], v[40:43]
  v_mfma_f32_16x16x32_bf16 v[44:47], v[48:51], v[236:239], v[44:47]
  v_and_b32 v52, v8, v23
  v_and_b32 v53, v9, v23
  v_and_b32 v54, v10, v23
  v_and_b32 v55, v11, v23
  s_nop 1
  v_mfma_f32_16x16x32_bf16 v[32:35], v[52:55], v[240:243], v[32:35]
  v_mfma_f32_16x16x32_bf16 v[36:39], v[52:55], v[244:247], v[36:39]
  v_mfma_f32_16x16x32_bf16 v[40:43], v[52:55], v[248:251], v[40:43]
  v_mfma_f32_16x16x32_bf16 v[44:47], v[52:55], v[252:255], v[44:47]
  s_waitcnt vmcnt(0)
  v_and_b32 v48, v8, v24
  v_and_b32 v49, v9, v24
  v_and_b32 v50, v10, v24
  v_and_b32 v51, v11, v24
  s_nop 1
  v_mfma_f32_16x16x32_bf16 v[32:35], v[48:51], v[64:67], v[32:35]
  v_mfma_f32_16x16x32_bf16 v[36:39], v[48:51], v[68:71], v[36:39]
  v_mfma_f32_16x16x32_bf16 v[40:43], v[48:51], v[72:75], v[40:43]
  v_mfma_f32_16x16x32_bf16 v[44:47], v[48:51], v[76:79], v[44:47]
  v_and_b32 v52, v8, v25
  v_and_b32 v53, v9, v25
  v_and_b32 v54, v10, v25
  v_and_b32 v55, v11, v25
  s_nop 1
  v_mfma_f32_16x16x32_bf16 v[32:35], v[52:55], v[80:83], v[32:35]
  v_mfma_f32_16x16x32_bf16 v[36:39], v[52:55], v[84:87], v[36:39]
  v_mfma_f32_16x16x32_bf16 v[40:43], v[52:55], v[88:91], v[40:43]
  v_mfma_f32_16x16x32_bf16 v[44:47], v[52:55], v[92:95], v[44:47]
  v_and_b32 v48, v8, v26
  v_and_b32 v49, v9, v26
  v_and_b32 v50, v10, v26
  v_and_b32 v51, v11, v26
  s_nop 1
  v_mfma_f32_16x16x32_bf16 v[32:35], v[48:51], v[96:99], v[32:35]
  v_mfma_f32_16x16x32_bf16 v[36:39], v[48:51], v[100:103], v[36:39]
  v_mfma_f32_16x16x32_bf16 v[40:43], v[48:51], v[104:107], v[40:43]
  v_mfma_f32_16x16x32_bf16 v[44:47], v[48:51], v[108:111], v[44:47]
  v_and_b32 v52, v8, v27
  v_and_b32 v53, v9, v27
  v_and_b32 v54, v10, v27
  v_and_b32 v55, v11, v27
  s_nop 1
  v_mfma_f32_16x16x32_bf16 v[32:35], v[52:55], v[112:115], v[32:35]
  v_mfma_f32_16x16x32_bf16 v[36:39], v[52:55], v[116:119], v[36:39]
  v_mfma_f32_16x16x32_bf16 v[40:43], v[52:55], v[120:123], v[40:43]
  v_mfma_f32_16x16x32_bf16 v[44:47], v[52:55], v[124:127], v[44:47]
  v_mov_b32 v65, s34
  v_mov_b32 v67, s34
  v_mov_b32 v69, s34
  v_mov_b32 v71, s34
  v_mov_b32 v73, s34
  v_mov_b32 v75, s34
  v_mov_b32 v77, s34
  v_mov_b32 v79, s34
  v_cmp_lt_u32 s[78:79], 31, v0
  v_lshlrev_b32 v6, 6, v4
  v_and_b32 v7, 1, v5
  v_lshl_add_u32 v6, v7, 5, v6
  v_lshrrev_b32 v7, 1, v5
  v_lshl_add_u32 v6, v7, 4, v6
  s_add_u32 s31, s33, 256
  s_mul_i32 s31, s31, 3584
  s_add_u32 s31, s31, 2162688
  s_nop 1
  v_cndmask_b32 v64, v32, v34, s[78:79]
  v_cndmask_b32 v66, v33, v35, s[78:79]
  buffer_store_dwordx4 v[64:67], v6, s[16:19], s31 offen offset:0 sc1
  v_cndmask_b32 v68, v36, v38, s[78:79]
  v_cndmask_b32 v70, v37, v39, s[78:79]
  buffer_store_dwordx4 v[68:71], v6, s[16:19], s31 offen offset:1024 sc1
  v_cndmask_b32 v72, v40, v42, s[78:79]
  v_cndmask_b32 v74, v41, v43, s[78:79]
  buffer_store_dwordx4 v[72:75], v6, s[16:19], s31 offen offset:2048 sc1
  v_cndmask_b32 v76, v44, v46, s[78:79]
  v_cndmask_b32 v78, v45, v47, s[78:79]
  s_mov_b32 exec_lo, 0xff00ff
  s_mov_b32 exec_hi, 0xff00ff
  buffer_store_dwordx4 v[76:79], v6, s[16:19], s31 offen offset:3072 sc1
  s_mov_b64 exec, -1
  s_waitcnt vmcnt(0)
  s_mov_b32 s32, 2
  s_branch L_prefetch
L_control:
  s_mov_b32 s20, s36
  s_and_b32 s21, s37, 0xffff
  s_mov_b32 s22, 896
  s_mov_b32 s23, 0x00020000
  v_lshlrev_b32 v1, 4, v0
  s_cmp_lg_u32 s28, 0
  s_cbranch_scc1 L_x_35
  buffer_load_dwordx4 v[8:11], v1, s[20:23], 0 offen nt
L_x_35:
  v_mov_b32 v4, -1
  v_mov_b32 v5, -1
  v_mov_b32 v6, -1
  v_mov_b32 v7, -1
  ds_write_b128 v1, v[4:7] offset:64
  ds_write_b128 v1, v[4:7] offset:1088
  ds_write_b128 v1, v[4:7] offset:2112
  ds_write_b128 v1, v[4:7] offset:3136
  ds_write_b128 v1, v[4:7] offset:4160
  ds_write_b128 v1, v[4:7] offset:5184
  ds_write_b128 v1, v[4:7] offset:6208
  ds_write_b128 v1, v[4:7] offset:7232
  ds_write_b128 v1, v[4:7] offset:8256
  ds_write_b128 v1, v[4:7] offset:9280
  ds_write_b128 v1, v[4:7] offset:10304
  ds_write_b128 v1, v[4:7] offset:11328
  ds_write_b128 v1, v[4:7] offset:12352
  ds_write_b128 v1, v[4:7] offset:13376
  v_mov_b32 v2, 0
  v_mov_b32 v3, 0
  ds_write_b64 v2, v[2:3] offset:0
  s_waitcnt lgkmcnt(0)
  s_barrier
  s_waitcnt lgkmcnt(0)
  s_add_u32 s34, s35, 1
  s_cmp_lg_u32 s28, 0
  s_cbranch_scc1 L_cpollq
  s_and_b32 s30, s29, 7
  s_cmp_lg_u32 s30, 0
  s_cbranch_scc1 L_cln
  s_mov_b32 exec_lo, 0x1ff
  s_mov_b32 exec_hi, 0x0
  v_lshlrev_b32 v3, 8, v0
  s_lshl_b32 s30, s29, 9
  s_add_u32 s31, s30, 32768
  buffer_store_dword v2, v3, s[16:19], s31 offen sc1
  s_mov_b64 exec, -1
L_cln:
  s_waitcnt vmcnt(0)
  v_lshlrev_b32 v12, 16, v8
  v_and_b32 v13, 0xffff0000, v8
  v_lshlrev_b32 v14, 16, v9
  v_and_b32 v15, 0xffff0000, v9
  v_lshlrev_b32 v16, 16, v10
  v_and_b32 v17, 0xffff0000, v10
  v_lshlrev_b32 v18, 16, v11
  v_and_b32 v19, 0xffff0000, v11
  v_add_f32 v20, v12, v13
  v_add_f32 v20, v20, v14
  v_add_f32 v20, v20, v15
  v_add_f32 v20, v20, v16
  v_add_f32 v20, v20, v17
  v_add_f32 v20, v20, v18
  v_add_f32 v20, v20, v19
  s_nop 1
  v_add_f32_dpp v20, v20, v20 quad_perm:[1,0,3,2] row_mask:0xf bank_mask:0xf
  s_nop 1
  v_add_f32_dpp v20, v20, v20 quad_perm:[2,3,0,1] row_mask:0xf bank_mask:0xf
  s_nop 1
  v_add_f32_dpp v20, v20, v20 row_half_mirror row_mask:0xf bank_mask:0xf
  s_nop 1
  v_add_f32_dpp v20, v20, v20 row_mirror row_mask:0xf bank_mask:0xf
  v_mov_b32 v21, v20
  s_nop 1
  v_permlane16_swap_b32 v21, v20
  s_nop 0
  v_add_f32 v20, v21, v20
  v_mov_b32 v21, v20
  s_nop 1
  v_permlane32_swap_b32 v21, v20
  s_nop 0
  v_add_f32 v20, v21, v20
  v_mul_f32 v20, 0x3b124925, v20
  v_cmp_gt_u32 vcc, 56, v0
  v_mov_b32 v22, 0
  v_sub_f32 v23, v12, v20
  v_fmac_f32 v22, v23, v23
  v_sub_f32 v23, v13, v20
  v_fmac_f32 v22, v23, v23
  v_sub_f32 v23, v14, v20
  v_fmac_f32 v22, v23, v23
  v_sub_f32 v23, v15, v20
  v_fmac_f32 v22, v23, v23
  v_sub_f32 v23, v16, v20
  v_fmac_f32 v22, v23, v23
  v_sub_f32 v23, v17, v20
  v_fmac_f32 v22, v23, v23
  v_sub_f32 v23, v18, v20
  v_fmac_f32 v22, v23, v23
  v_sub_f32 v23, v19, v20
  v_fmac_f32 v22, v23, v23
  v_cndmask_b32 v22, 0, v22, vcc
  s_nop 1
  v_add_f32_dpp v22, v22, v22 quad_perm:[1,0,3,2] row_mask:0xf bank_mask:0xf
  s_nop 1
  v_add_f32_dpp v22, v22, v22 quad_perm:[2,3,0,1] row_mask:0xf bank_mask:0xf
  s_nop 1
  v_add_f32_dpp v22, v22, v22 row_half_mirror row_mask:0xf bank_mask:0xf
  s_nop 1
  v_add_f32_dpp v22, v22, v22 row_mirror row_mask:0xf bank_mask:0xf
  v_mov_b32 v21, v22
  s_nop 1
  v_permlane16_swap_b32 v21, v22
  s_nop 0
  v_add_f32 v22, v21, v22
  v_mov_b32 v21, v22
  s_nop 1
  v_permlane32_swap_b32 v21, v22
  s_nop 0
  v_add_f32 v22, v21, v22
  v_mul_f32 v22, 0x3b124925, v22
  v_cvt_pk_bf16_f32 v22, v22, v22
  v_and_b32 v22, 0xffff0000, v22
  v_cvt_pk_bf16_f32 v20, v20, v20
  v_and_b32 v20, 0xffff0000, v20
  v_add_f32 v22, 0x3727c5ac, v22
  v_cvt_pk_bf16_f32 v22, v22, v22
  v_and_b32 v22, 0xffff0000, v22
  v_sqrt_f32 v22, v22
  s_nop 0
  v_cvt_pk_bf16_f32 v22, v22, v22
  v_and_b32 v22, 0xffff0000, v22
  v_rcp_f32 v23, v22
  s_nop 0
  v_sub_f32 v12, v12, v20
  v_cvt_pk_bf16_f32 v12, v12, v12
  v_and_b32 v12, 0xffff0000, v12
  v_mul_f32 v24, v12, v23
  v_fma_f32 v25, -v24, v22, v12
  v_fma_f32 v24, v25, v23, v24
  v_cvt_pk_bf16_f32 v12, v24, v24
  v_sub_f32 v13, v13, v20
  v_cvt_pk_bf16_f32 v13, v13, v13
  v_and_b32 v13, 0xffff0000, v13
  v_mul_f32 v24, v13, v23
  v_fma_f32 v25, -v24, v22, v13
  v_fma_f32 v24, v25, v23, v24
  v_cvt_pk_bf16_f32 v13, v24, v24
  v_sub_f32 v14, v14, v20
  v_cvt_pk_bf16_f32 v14, v14, v14
  v_and_b32 v14, 0xffff0000, v14
  v_mul_f32 v24, v14, v23
  v_fma_f32 v25, -v24, v22, v14
  v_fma_f32 v24, v25, v23, v24
  v_cvt_pk_bf16_f32 v14, v24, v24
  v_sub_f32 v15, v15, v20
  v_cvt_pk_bf16_f32 v15, v15, v15
  v_and_b32 v15, 0xffff0000, v15
  v_mul_f32 v24, v15, v23
  v_fma_f32 v25, -v24, v22, v15
  v_fma_f32 v24, v25, v23, v24
  v_cvt_pk_bf16_f32 v15, v24, v24
  v_sub_f32 v16, v16, v20
  v_cvt_pk_bf16_f32 v16, v16, v16
  v_and_b32 v16, 0xffff0000, v16
  v_mul_f32 v24, v16, v23
  v_fma_f32 v25, -v24, v22, v16
  v_fma_f32 v24, v25, v23, v24
  v_cvt_pk_bf16_f32 v16, v24, v24
  v_sub_f32 v17, v17, v20
  v_cvt_pk_bf16_f32 v17, v17, v17
  v_and_b32 v17, 0xffff0000, v17
  v_mul_f32 v24, v17, v23
  v_fma_f32 v25, -v24, v22, v17
  v_fma_f32 v24, v25, v23, v24
  v_cvt_pk_bf16_f32 v17, v24, v24
  v_sub_f32 v18, v18, v20
  v_cvt_pk_bf16_f32 v18, v18, v18
  v_and_b32 v18, 0xffff0000, v18
  v_mul_f32 v24, v18, v23
  v_fma_f32 v25, -v24, v22, v18
  v_fma_f32 v24, v25, v23, v24
  v_cvt_pk_bf16_f32 v18, v24, v24
  v_sub_f32 v19, v19, v20
  v_cvt_pk_bf16_f32 v19, v19, v19
  v_and_b32 v19, 0xffff0000, v19
  v_mul_f32 v24, v19, v23
  v_fma_f32 v25, -v24, v22, v19
  v_fma_f32 v24, v25, v23, v24
  v_cvt_pk_bf16_f32 v19, v24, v24
  v_lshlrev_b32 v26, 5, v0
  s_mov_b32 exec_lo, 0xffffffff
  s_mov_b32 exec_hi, 0xffffff
  ds_write_b128 v26, v[12:15] offset:14592
  ds_write_b128 v26, v[16:19] offset:14608
  s_mov_b64 exec, -1
  s_waitcnt lgkmcnt(0)
  s_barrier
  v_and_b32 v2, 7, v0
  v_bfe_u32 v3, v0, 3, 1
  v_lshl_add_u32 v2, v3, 4, v2
  v_lshlrev_b32 v2, 4, v2
  v_mov_b32 v17, s34
  v_mov_b32 v19, s34
  v_and_b32 v4, 7, v0
  v_lshlrev_b32 v4, 5, v4
  v_lshl_add_u32 v4, v3, 4, v4
  s_lshl_b32 s31, s29, 8
  s_add_u32 s31, s31, 4096
  s_barrier
  ds_read_b128 v[32:35], v2 offset:17664
  ds_read_b128 v[36:39], v2 offset:18304
  ds_read_b128 v[40:43], v2 offset:18688
  ds_read_b128 v[44:47], v2 offset:19328
  ds_read_b128 v[48:51], v2 offset:19712
  ds_read_b128 v[52:55], v2 offset:20352
  ds_read_b128 v[56:59], v2 offset:20736
  ds_read_b128 v[60:63], v2 offset:21376
  ds_read_b128 v[64:67], v2 offset:21760
  ds_read_b128 v[68:71], v2 offset:22400
  ds_read_b128 v[72:75], v2 offset:22784
  ds_read_b128 v[76:79], v2 offset:23424
  ds_read_b128 v[80:83], v2 offset:23808
  ds_read_b128 v[84:87], v2 offset:24448
  s_waitcnt lgkmcnt(0)
  v_add_f32 v12, v32, v36
  v_add_f32 v13, v33, v37
  v_add_f32 v14, v34, v38
  v_add_f32 v15, v35, v39
  v_add_f32 v40, v40, v44
  v_add_f32 v41, v41, v45
  v_add_f32 v42, v42, v46
  v_add_f32 v43, v43, v47
  v_add_f32 v12, v12, v40
  v_add_f32 v13, v13, v41
  v_add_f32 v14, v14, v42
  v_add_f32 v15, v15, v43
  v_add_f32 v48, v48, v52
  v_add_f32 v49, v49, v53
  v_add_f32 v50, v50, v54
  v_add_f32 v51, v51, v55
  v_add_f32 v12, v12, v48
  v_add_f32 v13, v13, v49
  v_add_f32 v14, v14, v50
  v_add_f32 v15, v15, v51
  v_add_f32 v56, v56, v60
  v_add_f32 v57, v57, v61
  v_add_f32 v58, v58, v62
  v_add_f32 v59, v59, v63
  v_add_f32 v12, v12, v56
  v_add_f32 v13, v13, v57
  v_add_f32 v14, v14, v58
  v_add_f32 v15, v15, v59
  v_add_f32 v64, v64, v68
  v_add_f32 v65, v65, v69
  v_add_f32 v66, v66, v70
  v_add_f32 v67, v67, v71
  v_add_f32 v12, v12, v64
  v_add_f32 v13, v13, v65
  v_add_f32 v14, v14, v66
  v_add_f32 v15, v15, v67
  v_add_f32 v72, v72, v76
  v_add_f32 v73, v73, v77
  v_add_f32 v74, v74, v78
  v_add_f32 v75, v75, v79
  v_add_f32 v12, v12, v72
  v_add_f32 v13, v13, v73
  v_add_f32 v14, v14, v74
  v_add_f32 v15, v15, v75
  v_add_f32 v80, v80, v84
  v_add_f32 v81, v81, v85
  v_add_f32 v82, v82, v86
  v_add_f32 v83, v83, v87
  v_add_f32 v12, v12, v80
  v_add_f32 v13, v13, v81
  v_add_f32 v14, v14, v82
  v_add_f32 v15, v15, v83
  v_cvt_pk_bf16_f32 v16, v12, v13
  v_cvt_pk_bf16_f32 v18, v14, v15
  s_mov_b32 exec_lo, 0xffff
  s_mov_b32 exec_hi, 0x0
  buffer_store_dwordx4 v[16:19], v4, s[16:19], s31 offen sc1
  s_mov_b64 exec, -1
  s_barrier
L_cpollq:
  v_lshlrev_b32 v2, 4, v0
  s_lshl_b32 s31, s4, 11
  s_add_u32 s31, s31, 4096
L_pollq_36:
  buffer_load_dwordx4 v[4:7], v2, s[16:19], s31 offen sc1
  buffer_load_dwordx4 v[8:11], v2, s[16:19], s31 offen offset:1024 sc1
  s_waitcnt vmcnt(0)
  v_xor_b32 v12, s34, v5
  v_xor_b32 v63, s34, v7
  v_or_b32 v12, v12, v63
  v_xor_b32 v63, s34, v9
  v_or_b32 v12, v12, v63
  v_xor_b32 v63, s34, v11
  v_or_b32 v12, v12, v63
  v_cmp_ne_u32 vcc, 0, v12
  s_nop 0
  s_cbranch_vccz L_pollqd_37
  s_branch L_pollq_36
L_pollqd_37:
  v_mov_b32 v5, v6
  v_mov_b32 v9, v10
  v_lshlrev_b32 v3, 3, v0
  ds_write_b64 v3, v[4:5] offset:16384
  ds_write_b64 v3, v[8:9] offset:16896
  v_mov_b32 v4, 1
  v_mov_b32 v5, 4
  s_waitcnt lgkmcnt(0)
  ds_write_b32 v5, v4
  v_and_b32 v1, 1, v0
  v_lshlrev_b32 v1, 4, v1
  v_mov_b32 v31, 0xffff
  v_lshlrev_b32 v31, v1, v31
  v_bfe_u32 v1, v0, 1, 2
  v_cmp_eq_u32 vcc, 0, v1
  s_nop 1
  v_cndmask_b32 v8, 0, v31, vcc
  v_cmp_eq_u32 vcc, 1, v1
  s_nop 1
  v_cndmask_b32 v9, 0, v31, vcc
  v_cmp_eq_u32 vcc, 2, v1
  s_nop 1
  v_cndmask_b32 v10, 0, v31, vcc
  v_cmp_eq_u32 vcc, 3, v1
  s_nop 1
  v_cndmask_b32 v11, 0, v31, vcc
  s_mov_b32 s66, 0
  s_mov_b32 s67, s6
  s_mov_b32 s77, 364
  s_mul_i32 s80, s6, 448
  s_add_u32 s80, s80, 84
  s_mov_b32 s79, 0
  s_mov_b32 s75, 0
  s_mov_b32 s78, 4
  s_mov_b32 s76, 3
  v_mov_b32 v13, 0
  v_lshlrev_b32 v17, 8, v0
  s_lshl_b32 s68, s4, 12
  s_add_u32 s68, s68, 32768
L_floop:
L_floop1:
  ds_read_b32 v14, v13
  s_waitcnt lgkmcnt(0)
  v_readfirstlane_b32 s70, v14
  s_nop 1
  s_sub_i32 s71, s66, s70
  s_cmp_le_i32 s71, s76
  s_cbranch_scc1 L_fgo0
  s_sleep 2
  s_branch L_floop1
L_fgo0:
  s_cmp_lg_u32 s75, 0
  s_cbranch_scc1 L_fnext
L_fgo:
  s_lshl_b32 s71, s67, 8
  v_mov_b32 v15, s71
  v_mov_b32 v12, s78
  s_mov_b64 exec, 1
  buffer_atomic_add v12, v15, s[16:19], s68 offen sc0 sc1
  s_cmp_eq_u32 s79, 0
  s_cbranch_scc1 L_fnog
  s_mov_b32 exec_lo, 0xff
  s_mov_b32 exec_hi, 0x0
  buffer_load_dword v16, v17, s[16:19], s68 offen sc1
L_fnog:
  s_waitcnt vmcnt(0)
  s_mov_b64 exec, 1
  v_readfirstlane_b32 s70, v12
  s_mov_b64 exec, -1
  s_nop 1
  s_cmp_lt_u32 s70, s77
  s_cbranch_scc1 L_fgot
  s_cmp_eq_u32 s79, 0
  s_cbranch_scc1 L_fnext
  v_mov_b32 v14, v16
  s_mov_b32 s75, 0
  s_branch L_fpick
L_fnext:
  s_mov_b32 s75, 0
  s_cmp_lg_u32 s79, 0
  s_cbranch_scc1 L_fsteal
  s_mov_b32 s79, 1
  s_mov_b32 s67, 8
  s_mov_b32 s77, 512
  s_mov_b32 s80, 3584
  s_branch L_fgo
L_fsteal:
  s_mov_b32 s79, 2
  s_mov_b32 s78, 4
  s_mov_b32 s76, 3
  v_lshlrev_b32 v15, 8, v0
  s_mov_b32 exec_lo, 0xff
  s_mov_b32 exec_hi, 0x0
  buffer_load_dword v14, v15, s[16:19], s68 offen sc1
  s_waitcnt vmcnt(0)
L_fpick:
  s_mov_b32 s79, 2
  s_mov_b32 s78, 4
  s_mov_b32 s76, 3
  s_mov_b32 exec_lo, 0xff
  s_mov_b32 exec_hi, 0x0
  v_cmp_gt_u32 vcc, 364, v14
  s_mov_b64 exec, -1
  s_nop 1
  s_and_b32 s71, vcc_lo, 0xff
  s_cmp_eq_u32 s71, 0
  s_cbranch_scc1 L_fend
  s_lshl_b32 s73, s71, 8
  s_or_b32 s73, s73, s71
  s_add_u32 s74, s6, 1
  s_lshr_b32 s73, s73, s74
  s_ff1_i32_b32 s73, s73
  s_add_u32 s67, s74, s73
  s_and_b32 s67, s67, 7
  s_mov_b32 s77, 364
  s_mul_i32 s80, s67, 448
  s_add_u32 s80, s80, 84
  s_branch L_fgo
L_fgot:
  s_sub_u32 s71, s77, s70
  s_min_u32 s71, s71, s78
  s_add_u32 s73, s80, s70
  v_add_u32 v14, s73, v0
  v_add_u32 v15, s66, v0
  v_lshlrev_b32 v15, 2, v15
  s_lshl_b32 s74, 1, s71
  s_sub_u32 s74, s74, 1
  s_mov_b32 exec_lo, s74
  s_mov_b32 exec_hi, 0
  ds_write_b32 v15, v14 offset:64
  s_mov_b64 exec, -1
  s_add_u32 s66, s66, s71
  s_add_u32 s70, s70, s71
  s_cmp_ge_u32 s70, s77
  s_cselect_b32 s75, 1, 0
  s_cmp_lg_u32 s79, 1
  s_cbranch_scc1 L_floop
  s_cmp_lt_u32 s70, 512
  s_cbranch_scc1 L_floop
  s_mov_b32 s78, 4
  s_mov_b32 s76, 3
  s_branch L_floop
L_fend:
  v_mov_b32 v14, 4096
  v_add_u32 v15, s66, v0
  v_lshlrev_b32 v15, 2, v15
  s_mov_b32 exec_lo, 0xff
  s_mov_b32 exec_hi, 0x0
  ds_write_b32 v15, v14 offset:64
  s_mov_b64 exec, -1
  s_mov_b32 s20, s44
  s_and_b32 s21, s45, 0xffff
  s_mov_b32 s22, 3670016
  s_mov_b32 s23, 0x00020000
  v_and_b32 v2, 15, v0
  v_lshrrev_b32 v3, 4, v0
  v_mul_u32_u24 v4, 896, v3
  v_lshl_add_u32 v4, v2, 4, v4
  s_lshl_b32 s30, s2, 4
  s_mul_i32 s30, s30, 896
  s_add_u32 s31, s30, 0
  buffer_load_dwordx4 v[128:131], v4, s[20:23], s31 offen offset:0 nt
  buffer_load_dwordx4 v[132:135], v4, s[20:23], s31 offen offset:256 nt
  buffer_load_dwordx4 v[136:139], v4, s[20:23], s31 offen offset:512 nt
  buffer_load_dwordx4 v[140:143], v4, s[20:23], s31 offen offset:768 nt
  s_add_u32 s31, s30, 3584
  buffer_load_dwordx4 v[144:147], v4, s[20:23], s31 offen offset:0 nt
  buffer_load_dwordx4 v[148:151], v4, s[20:23], s31 offen offset:256 nt
  buffer_load_dwordx4 v[152:155], v4, s[20:23], s31 offen offset:512 nt
  buffer_load_dwordx4 v[156:159], v4, s[20:23], s31 offen offset:768 nt
  s_add_u32 s31, s30, 7168
  buffer_load_dwordx4 v[160:163], v4, s[20:23], s31 offen offset:0 nt
  buffer_load_dwordx4 v[164:167], v4, s[20:23], s31 offen offset:256 nt
  buffer_load_dwordx4 v[168:171], v4, s[20:23], s31 offen offset:512 nt
  buffer_load_dwordx4 v[172:175], v4, s[20:23], s31 offen offset:768 nt
  s_add_u32 s31, s30, 10752
  buffer_load_dwordx4 v[176:179], v4, s[20:23], s31 offen offset:0 nt
  buffer_load_dwordx4 v[180:183], v4, s[20:23], s31 offen offset:256 nt
  buffer_load_dwordx4 v[184:187], v4, s[20:23], s31 offen offset:512 nt
  buffer_load_dwordx4 v[188:191], v4, s[20:23], s31 offen offset:768 nt
L_cbt1:
  v_lshrrev_b32 v96, 3, v0
  v_lshlrev_b32 v96, 13, v96
  v_and_b32 v3, 7, v0
  v_lshl_add_u32 v97, v3, 4, v96
  s_lshl_b32 s30, s4, 18
  s_add_u32 s30, s30, 65536
  s_lshl_b32 s81, s5, 7
  s_add_u32 s81, s81, s30
  s_lshr_b32 s85, s5, 4
  s_lshl_b32 s85, s85, 4
  s_add_u32 s85, s85, s30
  s_add_u32 s85, s85, 4096
  s_add_u32 s82, s81, 65536
  s_add_u32 s86, s85, 65536
  s_add_u32 s83, s81, 131072
  s_add_u32 s87, s85, 131072
  s_add_u32 s84, s81, 196608
  s_add_u32 s88, s85, 196608
  s_waitcnt lgkmcnt(0)
  s_barrier
L_poll1_38:
  buffer_load_dwordx4 v[32:35], v97, s[16:19], s81 offen sc1
  buffer_load_dwordx4 v[64:67], v96, s[16:19], s85 offen sc1
  buffer_load_dwordx4 v[36:39], v97, s[16:19], s82 offen sc1
  buffer_load_dwordx4 v[68:71], v96, s[16:19], s86 offen sc1
  buffer_load_dwordx4 v[40:43], v97, s[16:19], s83 offen sc1
  buffer_load_dwordx4 v[72:75], v96, s[16:19], s87 offen sc1
  buffer_load_dwordx4 v[44:47], v97, s[16:19], s84 offen sc1
  buffer_load_dwordx4 v[76:79], v96, s[16:19], s88 offen sc1
  s_waitcnt vmcnt(0)
  v_xor_b32 v12, s34, v33
  v_xor_b32 v63, s34, v35
  v_or_b32 v12, v12, v63
  v_xor_b32 v63, s34, v37
  v_or_b32 v12, v12, v63
  v_xor_b32 v63, s34, v39
  v_or_b32 v12, v12, v63
  v_xor_b32 v63, s34, v41
  v_or_b32 v12, v12, v63
  v_xor_b32 v63, s34, v43
  v_or_b32 v12, v12, v63
  v_xor_b32 v63, s34, v45
  v_or_b32 v12, v12, v63
  v_xor_b32 v63, s34, v47
  v_or_b32 v12, v12, v63
  v_xor_b32 v63, s34, v65
  v_or_b32 v12, v12, v63
  v_xor_b32 v63, s34, v67
  v_or_b32 v12, v12, v63
  v_xor_b32 v63, s34, v69
  v_or_b32 v12, v12, v63
  v_xor_b32 v63, s34, v71
  v_or_b32 v12, v12, v63
  v_xor_b32 v63, s34, v73
  v_or_b32 v12, v12, v63
  v_xor_b32 v63, s34, v75
  v_or_b32 v12, v12, v63
  v_xor_b32 v63, s34, v77
  v_or_b32 v12, v12, v63
  v_xor_b32 v63, s34, v79
  v_or_b32 v12, v12, v63
  v_cmp_ne_u32 vcc, 0, v12
  s_nop 0
  s_cbranch_vccz L_poll1d_39
  s_mov_b64 exec, vcc
  s_sleep 1
  s_branch L_poll1_38
L_poll1d_39:
  s_mov_b64 exec, -1
  v_max3_f32 v48, v64, v68, v72
  v_max_f32 v48, v48, v76
  s_nop 1
  v_max_f32_dpp v48, v48, v48 row_ror:8 row_mask:0xf bank_mask:0xf
  v_mov_b32 v49, v48
  s_nop 1
  v_permlane16_swap_b32 v49, v48
  s_nop 0
  v_max_f32 v48, v49, v48
  v_mov_b32 v49, v48
  s_nop 1
  v_permlane32_swap_b32 v49, v48
  s_nop 0
  v_max_f32 v48, v49, v48
  v_sub_f32 v64, v64, v48
  v_mul_f32 v64, s60, v64
  v_exp_f32 v64, v64
  v_sub_f32 v68, v68, v48
  v_mul_f32 v68, s60, v68
  v_exp_f32 v68, v68
  v_sub_f32 v72, v72, v48
  v_mul_f32 v72, s60, v72
  v_exp_f32 v72, v72
  v_sub_f32 v76, v76, v48
  v_mul_f32 v76, s60, v76
  v_exp_f32 v76, v76
  s_nop 0
  v_mul_f32 v50, v64, v66
  v_mul_f32 v51, v64, v32
  v_mul_f32 v52, v64, v34
  v_fmac_f32 v50, v68, v70
  v_fmac_f32 v51, v68, v36
  v_fmac_f32 v52, v68, v38
  v_fmac_f32 v50, v72, v74
  v_fmac_f32 v51, v72, v40
  v_fmac_f32 v52, v72, v42
  v_fmac_f32 v50, v76, v78
  v_fmac_f32 v51, v76, v44
  v_fmac_f32 v52, v76, v46
  s_nop 1
  v_add_f32_dpp v50, v50, v50 row_ror:8 row_mask:0xf bank_mask:0xf
  v_add_f32_dpp v51, v51, v51 row_ror:8 row_mask:0xf bank_mask:0xf
  v_add_f32_dpp v52, v52, v52 row_ror:8 row_mask:0xf bank_mask:0xf
  v_mov_b32 v53, v50
  v_mov_b32 v54, v51
  v_mov_b32 v55, v52
  s_nop 1
  v_permlane16_swap_b32 v53, v50
  v_permlane16_swap_b32 v54, v51
  v_permlane16_swap_b32 v55, v52
  s_nop 0
  v_add_f32 v50, v53, v50
  v_add_f32 v51, v54, v51
  v_add_f32 v52, v55, v52
  v_mov_b32 v53, v50
  v_mov_b32 v54, v51
  v_mov_b32 v55, v52
  s_nop 1
  v_permlane32_swap_b32 v53, v50
  v_permlane32_swap_b32 v54, v51
  v_permlane32_swap_b32 v55, v52
  s_nop 0
  v_add_f32 v50, v53, v50
  v_add_f32 v51, v54, v51
  v_add_f32 v52, v55, v52
  v_rcp_f32 v53, v50
  s_nop 0
  v_mul_f32 v54, v51, v53
  v_fma_f32 v55, -v54, v50, v51
  v_fma_f32 v51, v55, v53, v54
  v_mul_f32 v54, v52, v53
  v_fma_f32 v55, -v54, v50, v52
  v_fma_f32 v52, v55, v53, v54
  v_lshrrev_b32 v3, 4, v0
  v_and_b32 v5, 1, v3
  v_cmp_eq_u32 vcc, 1, v5
  s_nop 1
  v_cndmask_b32 v51, v51, v52, vcc
  v_cvt_pk_bf16_f32 v51, v51, v51
  s_nop 1
  v_mov_b32_dpp v40, v51 row_newbcast:0 row_mask:0x3 bank_mask:0xf
  v_mov_b32_dpp v40, v51 row_newbcast:1 row_mask:0xc bank_mask:0xf
  v_mov_b32_dpp v41, v51 row_newbcast:2 row_mask:0x3 bank_mask:0xf
  v_mov_b32_dpp v41, v51 row_newbcast:3 row_mask:0xc bank_mask:0xf
  v_mov_b32_dpp v42, v51 row_newbcast:4 row_mask:0x3 bank_mask:0xf
  v_mov_b32_dpp v42, v51 row_newbcast:5 row_mask:0xc bank_mask:0xf
  v_mov_b32_dpp v43, v51 row_newbcast:6 row_mask:0x3 bank_mask:0xf
  v_mov_b32_dpp v43, v51 row_newbcast:7 row_mask:0xc bank_mask:0xf
  v_mov_b32 v81, s34
  v_mov_b32 v83, s34
  v_mov_b32 v85, s34
  v_mov_b32 v87, s34
  v_mov_b32 v89, s34
  v_mov_b32 v91, s34
  v_mov_b32 v93, s34
  v_mov_b32 v95, s34
  v_cmp_lt_u32 s[78:79], 31, v0
  v_and_b32 v44, v8, v40
  v_and_b32 v45, v9, v40
  v_and_b32 v46, v10, v40
  v_and_b32 v47, v11, v40
  s_nop 1
  v_mfma_f32_16x16x32_bf16 v[64:67], v[44:47], v[128:131], 0
  v_mfma_f32_16x16x32_bf16 v[68:71], v[44:47], v[132:135], 0
  v_mfma_f32_16x16x32_bf16 v[72:75], v[44:47], v[136:139], 0
  v_mfma_f32_16x16x32_bf16 v[76:79], v[44:47], v[140:143], 0
  v_and_b32 v48, v8, v41
  v_and_b32 v49, v9, v41
  v_and_b32 v50, v10, v41
  v_and_b32 v51, v11, v41
  s_nop 1
  v_mfma_f32_16x16x32_bf16 v[64:67], v[48:51], v[144:147], v[64:67]
  v_mfma_f32_16x16x32_bf16 v[68:71], v[48:51], v[148:151], v[68:71]
  v_mfma_f32_16x16x32_bf16 v[72:75], v[48:51], v[152:155], v[72:75]
  v_mfma_f32_16x16x32_bf16 v[76:79], v[48:51], v[156:159], v[76:79]
  v_and_b32 v44, v8, v42
  v_and_b32 v45, v9, v42
  v_and_b32 v46, v10, v42
  v_and_b32 v47, v11, v42
  s_nop 1
  v_mfma_f32_16x16x32_bf16 v[64:67], v[44:47], v[160:163], v[64:67]
  v_mfma_f32_16x16x32_bf16 v[68:71], v[44:47], v[164:167], v[68:71]
  v_mfma_f32_16x16x32_bf16 v[72:75], v[44:47], v[168:171], v[72:75]
  v_mfma_f32_16x16x32_bf16 v[76:79], v[44:47], v[172:175], v[76:79]
  v_and_b32 v48, v8, v43
  v_and_b32 v49, v9, v43
  v_and_b32 v50, v10, v43
  v_and_b32 v51, v11, v43
  s_nop 1
  v_mfma_f32_16x16x32_bf16 v[64:67], v[48:51], v[176:179], v[64:67]
  v_mfma_f32_16x16x32_bf16 v[68:71], v[48:51], v[180:183], v[68:71]
  v_mfma_f32_16x16x32_bf16 v[72:75], v[48:51], v[184:187], v[72:75]
  v_mfma_f32_16x16x32_bf16 v[76:79], v[48:51], v[188:191], v[76:79]
  v_and_b32 v2, 15, v0
  v_lshlrev_b32 v4, 6, v2
  v_and_b32 v5, 1, v3
  v_lshl_add_u32 v4, v5, 5, v4
  v_lshrrev_b32 v5, 1, v3
  v_lshl_add_u32 v4, v5, 4, v4
  s_mul_i32 s31, s2, 3584
  s_add_u32 s31, s31, 2162688
  s_nop 1
  v_cndmask_b32 v80, v64, v66, s[78:79]
  v_cndmask_b32 v82, v65, v67, s[78:79]
  buffer_store_dwordx4 v[80:83], v4, s[16:19], s31 offen offset:0 sc1
  v_cndmask_b32 v84, v68, v70, s[78:79]
  v_cndmask_b32 v86, v69, v71, s[78:79]
  buffer_store_dwordx4 v[84:87], v4, s[16:19], s31 offen offset:1024 sc1
  v_cndmask_b32 v88, v72, v74, s[78:79]
  v_cndmask_b32 v90, v73, v75, s[78:79]
  buffer_store_dwordx4 v[88:91], v4, s[16:19], s31 offen offset:2048 sc1
  v_cndmask_b32 v92, v76, v78, s[78:79]
  v_cndmask_b32 v94, v77, v79, s[78:79]
  s_mov_b32 exec_lo, 0xff00ff
  s_mov_b32 exec_hi, 0xff00ff
  buffer_store_dwordx4 v[92:95], v4, s[16:19], s31 offen offset:3072 sc1
  s_mov_b64 exec, -1
  s_cmp_ge_u32 s89, 112
  s_cbranch_scc1 L_cend
  s_barrier
  s_mov_b32 s20, s54
  s_and_b32 s21, s55, 0xffff
  s_mov_b32 s22, 896
  s_mov_b32 s23, 0x00020000
  v_mov_b32 v2, 41984
  s_barrier
  ds_read_b128 v[112:115], v2 offset:64
  ds_read_b64 v[120:121], v2 offset:80
  ds_read_b128 v[32:35], v2 offset:0
  ds_read_b128 v[36:39], v2 offset:16
  ds_read_b128 v[40:43], v2 offset:32
  ds_read_b128 v[44:47], v2 offset:48
  s_waitcnt lgkmcnt(0)
  v_lshlrev_b32 v48, 16, v120
  v_and_b32 v49, 0xffff0000, v120
  v_lshlrev_b32 v50, 16, v121
  v_and_b32 v51, 0xffff0000, v121
  v_add_f32 v32, v32, v36
  v_add_f32 v40, v40, v44
  v_add_f32 v32, v32, v40
  v_cvt_pk_bf16_f32 v32, v32, v32
  v_and_b32 v32, 0xffff0000, v32
  v_add_f32 v32, v48, v32
  v_cvt_pk_bf16_f32 v32, v32, v32
  v_and_b32 v32, 0xffff0000, v32
  v_add_f32 v32, v32, v112
  v_add_f32 v33, v33, v37
  v_add_f32 v41, v41, v45
  v_add_f32 v33, v33, v41
  v_cvt_pk_bf16_f32 v33, v33, v33
  v_and_b32 v33, 0xffff0000, v33
  v_add_f32 v33, v49, v33
  v_cvt_pk_bf16_f32 v33, v33, v33
  v_and_b32 v33, 0xffff0000, v33
  v_add_f32 v33, v33, v113
  v_add_f32 v34, v34, v38
  v_add_f32 v42, v42, v46
  v_add_f32 v34, v34, v42
  v_cvt_pk_bf16_f32 v34, v34, v34
  v_and_b32 v34, 0xffff0000, v34
  v_add_f32 v34, v50, v34
  v_cvt_pk_bf16_f32 v34, v34, v34
  v_and_b32 v34, 0xffff0000, v34
  v_add_f32 v34, v34, v114
  v_add_f32 v35, v35, v39
  v_add_f32 v43, v43, v47
  v_add_f32 v35, v35, v43
  v_cvt_pk_bf16_f32 v35, v35, v35
  v_and_b32 v35, 0xffff0000, v35
  v_add_f32 v35, v51, v35
  v_cvt_pk_bf16_f32 v35, v35, v35
  v_and_b32 v35, 0xffff0000, v35
  v_add_f32 v35, v35, v115
  v_cvt_pk_bf16_f32 v32, v32, v33
  v_cvt_pk_bf16_f32 v33, v34, v35
  s_lshl_b32 s31, s89, 3
  v_mov_b32 v2, 0
  s_mov_b64 exec, 1
  buffer_store_dwordx2 v[32:33], v2, s[20:23], s31 offen
  s_cmp_lg_u32 s89, 0
  s_cbranch_scc1 L_e_40
  v_mov_b32 v4, s34
  buffer_store_dword v4, v2, s[16:19], 0 offen offset:0
L_e_40:
  s_mov_b64 exec, -1
L_cend:
  s_branch L_end
L_end:
  s_endpgm
.section .rodata,"a"
.p2align 6
.amdhsa_kernel parallel_sum__gqa_block_cached__glu_gated_reglu__decode_kernel
  .amdhsa_next_free_vgpr 256
  .amdhsa_next_free_sgpr 100
  .amdhsa_accum_offset 256
  .amdhsa_group_segment_fixed_size 0
  .amdhsa_kernarg_size 96
  .amdhsa_user_sgpr_count 2
  .amdhsa_user_sgpr_kernarg_segment_ptr 1
  .amdhsa_system_sgpr_workgroup_id_x 1
.end_amdhsa_kernel
```
